```python
import torch

def _softmax(x, axis=-1):
    return torch.softmax(x, dim=axis)

def _gelu(x):
    return torch.nn.functional.gelu(x, approximate='tanh')

def _silu(x):
    return torch.nn.functional.silu(x)

def _sigmoid(x):
    return torch.sigmoid(x)

def _layernorm(x, axis=-1, eps=1e-05):
    m = x.mean(dim=axis, keepdim=True)
    v = x.var(dim=axis, keepdim=True, unbiased=False)
    return (x - m) / torch.sqrt(v + eps)

def _scatter_add(tgt, idx, src, axis=0):
    return tgt.clone().index_add_(axis, idx, src)

def _segment_sum(src, seg, n):
    out = torch.zeros((n,) + src.shape[1:], dtype=src.dtype)
    return out.index_add_(0, seg, src)

def _pad(x, pw):
    flat = tuple((v for pair in reversed(pw) for v in pair))
    return torch.nn.functional.pad(x, flat)
kernel_name = 'adaLN_cond__sliding_block_cached__geglu_ffn__decode'

def setup_inputs():

    _w = lambda a: (lambda t: t.to(torch.bfloat16) if t.is_floating_point() else t)(torch.as_tensor(a))

    def _A_setup():
        B, Sq, D = (2, 1, 640)
        Hq, Hkv, Sk, Dh = (32, 32, 16384, 128)
        assert Hq % Hkv == 0, (Hq, Hkv)
        return {'x': _w((lambda *s: torch.randn(*s, dtype=torch.bfloat16) * 0.05)(B, Sq, D)), 'k_cache': _w((lambda *s: torch.randn(*s, dtype=torch.bfloat16) * 0.8)(B, Hkv, Sk, Dh)), 'v_cache': _w((lambda *s: torch.randn(*s, dtype=torch.bfloat16) * 1.6)(B, Hkv, Sk, Dh)), 'wq': _w((lambda *s: torch.randn(*s, dtype=torch.bfloat16) * 0.8)(D, Hq * Dh) * D ** (-0.5)), 'wo': _w((lambda *s: torch.randn(*s, dtype=torch.bfloat16) * 1.6)(Hq * Dh, D) * (Hq * Dh) ** (-0.5))}
    _A_in = _A_setup()

    def _B_setup():
        B, S, D, F = (2, 1, 640, 1728)
        return {'x': _w((lambda *s: torch.randn(*s, dtype=torch.bfloat16) * 0.05)(B, S, D)), 'w_gate': _w((lambda *s: torch.randn(*s, dtype=torch.bfloat16) * 0.1)(D, F)), 'w_up': _w((lambda *s: torch.randn(*s, dtype=torch.bfloat16) * 0.1)(D, F)), 'w_down': _w((lambda *s: torch.randn(*s, dtype=torch.bfloat16) * 0.1)(F, D))}
    _B_in = _B_setup()
    return {'A_x': _A_in['x'], 'A_k_cache': _A_in['k_cache'], 'A_v_cache': _A_in['v_cache'], 'A_wq': _A_in['wq'], 'A_wo': _A_in['wo'], 'B_x': _B_in['x'], 'B_w_gate': _B_in['w_gate'], 'B_w_up': _B_in['w_up'], 'B_w_down': _B_in['w_down'], 'c': _w((lambda *s: torch.randn(*s, dtype=torch.bfloat16) * 0.4)(2, 640) * 8.0), 'w_mod': _w((lambda *s: torch.randn(*s, dtype=torch.bfloat16) * 0.4)(640, 6 * 640) * 640 ** (-0.5) * 8.0)}

def reference(A_x, A_k_cache, A_v_cache, A_wq, A_wo, B_x, B_w_gate, B_w_up, B_w_down, c, w_mod):

    def _A_ref(x, k_cache, v_cache, wq, wo):
        B, Sq, D = x.shape
        Hq, Dh = (32, 128)
        Hkv, Sk = (k_cache.shape[1], k_cache.shape[2])
        W = min(4096, max(256, Sk // 4))
        rep = Hq // Hkv
        q = (lambda x, *d: x.permute(*d))((x @ wq).reshape(B, Sq, Hq, Dh), 0, 2, 1, 3)
        k = (lambda x, n, axis: torch.repeat_interleave(x, n, dim=axis))(k_cache[:, :, Sk - W:, :], rep, axis=1)
        v = (lambda x, n, axis: torch.repeat_interleave(x, n, dim=axis))(v_cache[:, :, Sk - W:, :], rep, axis=1)
        scores = torch.einsum('bhqd,bhkd->bhqk', q, k) * Dh ** (-0.5)
        p = _softmax(scores, axis=-1)
        o = torch.einsum('bhqk,bhkd->bhqd', p, v)
        return (lambda x, *d: x.permute(*d))(o, 0, 2, 1, 3).reshape(B, Sq, Hq * Dh) @ wo

    def _B_ref(x, w_gate, w_up, w_down):
        return _gelu(x @ w_gate) * (x @ w_up) @ w_down
    x = A_x
    mod = (_silu(c) @ w_mod).reshape(c.shape[0], 6, 1, -1)
    sa, ca, ga, sb, cb, gb = (mod[:, 0].clone(), mod[:, 1].clone(), mod[:, 2].clone(), mod[:, 3].clone(), mod[:, 4].clone(), mod[:, 5].clone())
    h = _layernorm(x, axis=-1) * (1 + ca) + sa
    x = x + ga * _A_ref(h, A_k_cache, A_v_cache, A_wq, A_wo)
    h = _layernorm(x, axis=-1) * (1 + cb) + sb
    x = x + gb * _B_ref(h, B_w_gate, B_w_up, B_w_down)
    return x
```

```asm
; @launch grid=(256,1,1) block=(768,1,1) lds=123392
.amdgcn_target "amdgcn-amd-amdhsa--gfx950"
.text
.globl adaLN_cond__sliding_block_cached__geglu_ffn__decode_kernel
.p2align 8
.type adaLN_cond__sliding_block_cached__geglu_ffn__decode_kernel,@function
adaLN_cond__sliding_block_cached__geglu_ffn__decode_kernel:
L_code0:
    s_cmp_ge_u32 s2, 256
    s_cbranch_scc1 L_exit
    s_load_dwordx4 s[56:59], s[0:1], 8
    s_and_b32 s23, s2, 7
    s_lshr_b32 s24, s2, 3
    s_and_b32 s8, s23, 1
    s_lshl_b32 s8, s8, 2
    s_lshr_b32 s23, s23, 1
    s_or_b32 s23, s23, s8
    v_lshrrev_b32 v1, 6, v0
    v_and_b32 v0, 63, v0
    v_readfirstlane_b32 s3, v1
    s_cmp_ge_u32 s3, 8
    s_cbranch_scc1 L_helper
    v_and_b32 v1, 3, v0
    v_lshlrev_b32 v1, 4, v1
    v_lshrrev_b32 v3, 4, v0
    v_lshl_add_u32 v1, v3, 6, v1
    v_bfe_u32 v3, v0, 2, 2
    v_lshl_add_u32 v1, v3, 10, v1
    v_lshlrev_b32 v2, 4, v0
    s_bfe_u32 s8, s24, 0x20001
    s_lshl_b32 s9, s23, 2
    s_add_u32 s8, s8, s9
    s_and_b32 s9, s24, 1
    s_lshl_b32 s9, s9, 5
    s_add_u32 s8, s8, s9
    s_lshl_b32 s8, s8, 22
    s_lshr_b32 s9, s24, 3
    s_lshl_b32 s9, s9, 18
    s_add_u32 s8, s8, s9
    s_lshl_b32 s9, s3, 12
    s_add_u32 s8, s8, s9
    s_add_u32 s8, s8, 3145728
    s_cmp_lt_u32 s24, 5
    s_cselect_b32 s46, 1, 0
    s_cmp_lt_u32 s23, 4
    s_cselect_b32 s46, s46, 0
    s_waitcnt lgkmcnt(0)
    s_add_u32 s4, s56, s8
    s_addc_u32 s5, s57, 0
    s_add_u32 s6, s58, s8
    s_addc_u32 s7, s59, 0
    s_cmp_eq_u32 s46, 0
    s_cbranch_scc1 L_st_nb
    s_barrier
L_st_nb:
    global_load_dwordx4 v[40:43], v1, s[4:5] offset:0 nt
    global_load_dwordx4 v[44:47], v1, s[4:5] offset:256 nt
    global_load_dwordx4 v[48:51], v1, s[4:5] offset:512 nt
    global_load_dwordx4 v[52:55], v1, s[4:5] offset:768 nt
    s_add_u32 s4, s4, 32768
    s_addc_u32 s5, s5, 0
    s_cmp_eq_u32 s46, 1
    s_cbranch_scc1 L_st_nb2
    s_barrier
L_st_nb2:
    s_load_dwordx2 s[26:27], s[0:1], 104
    s_load_dwordx4 s[28:31], s[0:1], 48
    s_load_dwordx2 s[32:33], s[0:1], 64
    s_mul_i32 s34, s24, 43
    s_lshr_b32 s34, s34, 7
    s_mul_i32 s8, s34, 3
    s_sub_u32 s35, s24, s8
    s_sub_u32 s8, s24, 15
    s_cmp_ge_u32 s24, 15
    s_cselect_b32 s34, s8, s34
    s_cselect_b32 s35, 3, s35
    s_min_u32 s9, s23, 3
    s_mul_i32 s36, s23, 3
    s_add_u32 s36, s36, s9
    s_add_u32 s36, s36, s35
    s_cmp_lt_u32 s23, 3
    s_cselect_b32 s8, 20, 15
    s_cmp_lt_u32 s24, s8
    s_cselect_b32 s43, 1, 0
    s_mul_i32 s42, s23, 200704
    s_add_u32 s42, s42, 40960
    s_mul_i32 s25, s24, 6272
    s_add_u32 s25, s25, s42
    s_and_b32 s8, s24, 7
    s_lshr_b32 s9, s24, 3
    s_cmp_lt_u32 s8, 4
    s_cselect_b32 s10, 1, 3
    s_cmp_eq_u32 s9, s10
    s_cselect_b32 s52, 2, 0
    s_cmp_eq_u32 s9, 0
    s_cselect_b32 s52, 1, s52
    s_cmp_ge_u32 s23, 4
    s_cselect_b32 s10, 7, 8
    s_cmp_eq_u32 s8, s10
    s_cselect_b32 s52, 0, s52
    s_lshr_b32 s53, s24, 3
    s_lshl_b32 s53, s53, 18
    s_mov_b32 s44, 0x0
    s_sub_u32 s8, s24, 12
    s_cmp_ge_u32 s8, 16
    s_cselect_b32 s44, 0x0, s44
    s_cmp_lt_u32 s24, 8
    s_cselect_b32 s44, 0x0, s44
    s_cmp_eq_u32 s24, 7
    s_cselect_b32 s8, 0x0, s44
    s_cmp_ge_u32 s23, 4
    s_cselect_b32 s44, s8, s44
    s_cmp_eq_u32 s46, 1
    s_cselect_b32 s44, 0x0, s44
    s_cmp_ge_u32 s23, 4
    s_cselect_b32 s8, 16, 0
    s_lshr_b32 s44, s44, s8
    s_bfe_u32 s45, s44, 0x80008
    s_and_b32 s44, s44, 0xff
    s_mov_b32 s8, 0x0
    s_cmp_ge_u32 s23, 4
    s_cselect_b32 s8, 0x0, s8
    s_and_b32 s9, s23, 3
    s_lshl_b32 s9, s9, 3
    s_lshr_b32 s8, s8, s9
    s_and_b32 s8, s8, 0xff
    s_add_u32 s50, s8, 36
    s_mov_b32 s8, 0x0
    s_cmp_ge_u32 s23, 4
    s_cselect_b32 s8, 0x0, s8
    s_and_b32 s9, s23, 3
    s_lshl_b32 s9, s9, 3
    s_lshr_b32 s8, s8, s9
    s_and_b32 s8, s8, 0xff
    s_add_u32 s51, s8, 36
    s_cmp_le_u32 s44, 4
    s_cbranch_scc1 Lthr_1
    s_cmp_le_u32 s45, 4
    s_cbranch_scc1 Lthr_2
    s_waitcnt vmcnt(1)
Lthr_2:
    s_waitcnt vmcnt(2)
Lthr_1:
    s_waitcnt vmcnt(3)
    global_load_dwordx4 v[56:59], v1, s[4:5] offset:0 nt
    s_cmp_le_u32 s44, 5
    s_cbranch_scc1 Lthr_3
    s_cmp_le_u32 s45, 5
    s_cbranch_scc1 Lthr_4
    s_waitcnt vmcnt(1)
Lthr_4:
    s_waitcnt vmcnt(2)
Lthr_3:
    s_waitcnt vmcnt(3)
    global_load_dwordx4 v[60:63], v1, s[4:5] offset:256 nt
    s_cmp_le_u32 s44, 6
    s_cbranch_scc1 Lthr_5
    s_cmp_le_u32 s45, 6
    s_cbranch_scc1 Lthr_6
    s_waitcnt vmcnt(1)
Lthr_6:
    s_waitcnt vmcnt(2)
Lthr_5:
    s_waitcnt vmcnt(3)
    global_load_dwordx4 v[64:67], v1, s[4:5] offset:512 nt
    v_mov_b32 v24, 0
    v_mov_b32 v25, 1
    s_mov_b64 exec, 1
    ds_add_rtn_u32 v26, v24, v25 offset:48
    s_mov_b64 exec, -1
    s_waitcnt lgkmcnt(0)
    v_readfirstlane_b32 s8, v26
    s_cmp_ge_i32 s8, 10
    s_cbranch_scc1 Lc_8
    s_cmp_ge_i32 s8, -4
    s_cbranch_scc1 Lc_7
    s_waitcnt vmcnt(2)
Lc_7:
    s_waitcnt vmcnt(3)
Lc_8:
    s_waitcnt vmcnt(4)
    global_load_dwordx4 v[68:71], v1, s[4:5] offset:768 nt
    s_add_u32 s4, s4, 32768
    s_addc_u32 s5, s5, 0
    s_mov_b64 exec, 1
    ds_add_rtn_u32 v26, v24, v25 offset:48
    s_mov_b64 exec, -1
    s_waitcnt lgkmcnt(0)
    v_readfirstlane_b32 s8, v26
    s_cmp_ge_i32 s8, 18
    s_cbranch_scc1 Lc_11
    s_cmp_ge_i32 s8, 4
    s_cbranch_scc1 Lc_10
    s_waitcnt vmcnt(2)
Lc_10:
    s_waitcnt vmcnt(3)
Lc_11:
    s_waitcnt vmcnt(4)
    global_load_dwordx4 v[72:75], v1, s[4:5] offset:0 nt
    s_mov_b64 exec, 1
    ds_add_rtn_u32 v26, v24, v25 offset:48
    s_mov_b64 exec, -1
    s_waitcnt lgkmcnt(0)
    v_readfirstlane_b32 s8, v26
    s_cmp_ge_i32 s8, 26
    s_cbranch_scc1 Lc_14
    s_cmp_ge_i32 s8, 12
    s_cbranch_scc1 Lc_13
    s_waitcnt vmcnt(2)
Lc_13:
    s_waitcnt vmcnt(3)
Lc_14:
    s_waitcnt vmcnt(4)
    global_load_dwordx4 v[76:79], v1, s[4:5] offset:256 nt
    s_mov_b64 exec, 1
    ds_add_rtn_u32 v26, v24, v25 offset:48
    s_mov_b64 exec, -1
    s_waitcnt lgkmcnt(0)
    v_readfirstlane_b32 s8, v26
    s_cmp_ge_i32 s8, 34
    s_cbranch_scc1 Lc_17
    s_cmp_ge_i32 s8, 20
    s_cbranch_scc1 Lc_16
    s_waitcnt vmcnt(2)
Lc_16:
    s_waitcnt vmcnt(3)
Lc_17:
    s_waitcnt vmcnt(4)
    global_load_dwordx4 v[80:83], v1, s[4:5] offset:512 nt
    s_mov_b64 exec, 1
    ds_add_rtn_u32 v26, v24, v25 offset:48
    s_mov_b64 exec, -1
    s_waitcnt lgkmcnt(0)
    v_readfirstlane_b32 s8, v26
    s_cmp_ge_i32 s8, 42
    s_cbranch_scc1 Lc_20
    s_cmp_ge_i32 s8, 28
    s_cbranch_scc1 Lc_19
    s_waitcnt vmcnt(2)
Lc_19:
    s_waitcnt vmcnt(3)
Lc_20:
    s_waitcnt vmcnt(4)
    global_load_dwordx4 v[84:87], v1, s[4:5] offset:768 nt
    s_add_u32 s4, s4, 32768
    s_addc_u32 s5, s5, 0
    s_mov_b64 exec, 1
    ds_add_rtn_u32 v26, v24, v25 offset:48
    s_mov_b64 exec, -1
    s_waitcnt lgkmcnt(0)
    v_readfirstlane_b32 s8, v26
    s_cmp_ge_i32 s8, 50
    s_cbranch_scc1 Lc_23
    s_cmp_ge_i32 s8, 36
    s_cbranch_scc1 Lc_22
    s_waitcnt vmcnt(2)
Lc_22:
    s_waitcnt vmcnt(3)
Lc_23:
    s_waitcnt vmcnt(4)
    global_load_dwordx4 v[88:91], v1, s[4:5] offset:0 nt
    s_mov_b64 exec, 1
    ds_add_rtn_u32 v26, v24, v25 offset:48
    s_mov_b64 exec, -1
    s_waitcnt lgkmcnt(0)
    v_readfirstlane_b32 s8, v26
    s_cmp_ge_i32 s8, 58
    s_cbranch_scc1 Lc_26
    s_cmp_ge_i32 s8, 44
    s_cbranch_scc1 Lc_25
    s_waitcnt vmcnt(2)
Lc_25:
    s_waitcnt vmcnt(3)
Lc_26:
    s_waitcnt vmcnt(4)
    global_load_dwordx4 v[92:95], v1, s[4:5] offset:256 nt
    s_mov_b64 exec, 1
    ds_add_rtn_u32 v26, v24, v25 offset:48
    s_mov_b64 exec, -1
    s_waitcnt lgkmcnt(0)
    v_readfirstlane_b32 s8, v26
    s_cmp_ge_i32 s8, 66
    s_cbranch_scc1 Lc_29
    s_cmp_ge_i32 s8, 52
    s_cbranch_scc1 Lc_28
    s_waitcnt vmcnt(2)
Lc_28:
    s_waitcnt vmcnt(3)
Lc_29:
    s_waitcnt vmcnt(4)
    global_load_dwordx4 v[96:99], v1, s[4:5] offset:512 nt
    s_mov_b64 exec, 1
    ds_add_rtn_u32 v26, v24, v25 offset:48
    s_mov_b64 exec, -1
    s_waitcnt lgkmcnt(0)
    v_readfirstlane_b32 s8, v26
    s_cmp_ge_i32 s8, 74
    s_cbranch_scc1 Lc_32
    s_cmp_ge_i32 s8, 60
    s_cbranch_scc1 Lc_31
    s_waitcnt vmcnt(2)
Lc_31:
    s_waitcnt vmcnt(3)
Lc_32:
    s_waitcnt vmcnt(4)
    global_load_dwordx4 v[100:103], v1, s[4:5] offset:768 nt
    s_add_u32 s4, s4, 32768
    s_addc_u32 s5, s5, 0
    s_mov_b64 exec, 1
    ds_add_rtn_u32 v26, v24, v25 offset:48
    s_mov_b64 exec, -1
    s_waitcnt lgkmcnt(0)
    v_readfirstlane_b32 s8, v26
    s_cmp_ge_i32 s8, 82
    s_cbranch_scc1 Lc_35
    s_cmp_ge_i32 s8, 68
    s_cbranch_scc1 Lc_34
    s_waitcnt vmcnt(2)
Lc_34:
    s_waitcnt vmcnt(3)
Lc_35:
    s_waitcnt vmcnt(4)
    global_load_dwordx4 v[104:107], v1, s[4:5] offset:0 nt
    s_mov_b64 exec, 1
    ds_add_rtn_u32 v26, v24, v25 offset:48
    s_mov_b64 exec, -1
    v_mov_b32 v3, 0
    v_mov_b32 v6, 1
    s_mov_b64 s[16:17], exec
    s_mov_b64 exec, 1
    ds_add_u32 v3, v6 offset:44
    s_mov_b64 exec, s[16:17]
    s_waitcnt lgkmcnt(0)
    v_readfirstlane_b32 s8, v26
    s_cmp_ge_i32 s8, 90
    s_cbranch_scc1 Lc_38
    s_cmp_ge_i32 s8, 76
    s_cbranch_scc1 Lc_37
    s_waitcnt vmcnt(2)
Lc_37:
    s_waitcnt vmcnt(3)
Lc_38:
    s_waitcnt vmcnt(4)
    global_load_dwordx4 v[108:111], v1, s[4:5] offset:256 nt
    s_mov_b64 exec, 1
    ds_add_rtn_u32 v26, v24, v25 offset:48
    s_mov_b64 exec, -1
    s_waitcnt lgkmcnt(0)
    v_readfirstlane_b32 s8, v26
    s_cmp_ge_i32 s8, 98
    s_cbranch_scc1 Lc_41
    s_cmp_ge_i32 s8, 84
    s_cbranch_scc1 Lc_40
    s_waitcnt vmcnt(2)
Lc_40:
    s_waitcnt vmcnt(3)
Lc_41:
    s_waitcnt vmcnt(4)
    global_load_dwordx4 v[112:115], v1, s[4:5] offset:512 nt
    s_mov_b64 exec, 1
    ds_add_rtn_u32 v26, v24, v25 offset:48
    s_mov_b64 exec, -1
    s_waitcnt lgkmcnt(0)
    v_readfirstlane_b32 s8, v26
    s_cmp_ge_i32 s8, 106
    s_cbranch_scc1 Lc_44
    s_cmp_ge_i32 s8, 92
    s_cbranch_scc1 Lc_43
    s_waitcnt vmcnt(2)
Lc_43:
    s_waitcnt vmcnt(3)
Lc_44:
    s_waitcnt vmcnt(4)
    global_load_dwordx4 v[116:119], v1, s[4:5] offset:768 nt
    s_add_u32 s4, s4, 32768
    s_addc_u32 s5, s5, 0
    s_mov_b64 exec, 1
    ds_add_rtn_u32 v26, v24, v25 offset:48
    s_mov_b64 exec, -1
    s_waitcnt lgkmcnt(0)
    v_readfirstlane_b32 s8, v26
    s_cmp_ge_i32 s8, 114
    s_cbranch_scc1 Lc_47
    s_cmp_ge_i32 s8, 100
    s_cbranch_scc1 Lc_46
    s_waitcnt vmcnt(2)
Lc_46:
    s_waitcnt vmcnt(3)
Lc_47:
    s_waitcnt vmcnt(4)
    global_load_dwordx4 v[120:123], v1, s[4:5] offset:0 nt
    s_mov_b64 exec, 1
    ds_add_rtn_u32 v26, v24, v25 offset:48
    s_mov_b64 exec, -1
    s_waitcnt lgkmcnt(0)
    v_readfirstlane_b32 s8, v26
    s_cmp_ge_i32 s8, 122
    s_cbranch_scc1 Lc_50
    s_cmp_ge_i32 s8, 108
    s_cbranch_scc1 Lc_49
    s_waitcnt vmcnt(2)
Lc_49:
    s_waitcnt vmcnt(3)
Lc_50:
    s_waitcnt vmcnt(4)
    global_load_dwordx4 v[124:127], v1, s[4:5] offset:256 nt
    s_mov_b64 exec, 1
    ds_add_rtn_u32 v26, v24, v25 offset:48
    s_mov_b64 exec, -1
    s_waitcnt lgkmcnt(0)
    v_readfirstlane_b32 s8, v26
    s_cmp_ge_i32 s8, 130
    s_cbranch_scc1 Lc_53
    s_cmp_ge_i32 s8, 116
    s_cbranch_scc1 Lc_52
    s_waitcnt vmcnt(2)
Lc_52:
    s_waitcnt vmcnt(3)
Lc_53:
    s_waitcnt vmcnt(4)
    global_load_dwordx4 v[128:131], v1, s[4:5] offset:512 nt
    s_mov_b64 exec, 1
    ds_add_rtn_u32 v26, v24, v25 offset:48
    s_mov_b64 exec, -1
    v_mov_b32 v3, 0
    v_mov_b32 v6, 1
    s_mov_b64 s[16:17], exec
    s_mov_b64 exec, 1
    ds_add_u32 v3, v6 offset:36
    s_mov_b64 exec, s[16:17]
    s_waitcnt lgkmcnt(0)
    v_readfirstlane_b32 s8, v26
    s_cmp_ge_i32 s8, 138
    s_cbranch_scc1 Lc_56
    s_cmp_ge_i32 s8, 124
    s_cbranch_scc1 Lc_55
    s_waitcnt vmcnt(2)
Lc_55:
    s_waitcnt vmcnt(3)
Lc_56:
    s_waitcnt vmcnt(4)
    global_load_dwordx4 v[132:135], v1, s[4:5] offset:768 nt
    s_add_u32 s4, s4, 32768
    s_addc_u32 s5, s5, 0
    s_mov_b64 exec, 1
    ds_add_rtn_u32 v26, v24, v25 offset:48
    s_mov_b64 exec, -1
    s_waitcnt lgkmcnt(0)
    v_readfirstlane_b32 s8, v26
    s_cmp_ge_i32 s8, 146
    s_cbranch_scc1 Lc_59
    s_cmp_ge_i32 s8, 132
    s_cbranch_scc1 Lc_58
    s_waitcnt vmcnt(2)
Lc_58:
    s_waitcnt vmcnt(3)
Lc_59:
    s_waitcnt vmcnt(4)
    global_load_dwordx4 v[136:139], v1, s[4:5] offset:0 nt
    s_mov_b64 exec, 1
    ds_add_rtn_u32 v26, v24, v25 offset:48
    s_mov_b64 exec, -1
    s_waitcnt lgkmcnt(0)
    v_readfirstlane_b32 s8, v26
    s_cmp_ge_i32 s8, 154
    s_cbranch_scc1 Lc_62
    s_cmp_ge_i32 s8, 140
    s_cbranch_scc1 Lc_61
    s_waitcnt vmcnt(2)
Lc_61:
    s_waitcnt vmcnt(3)
Lc_62:
    s_waitcnt vmcnt(4)
    global_load_dwordx4 v[140:143], v1, s[4:5] offset:256 nt
    s_mov_b64 exec, 1
    ds_add_rtn_u32 v26, v24, v25 offset:48
    s_mov_b64 exec, -1
    s_waitcnt lgkmcnt(0)
    v_readfirstlane_b32 s8, v26
    s_cmp_ge_i32 s8, 162
    s_cbranch_scc1 Lc_65
    s_cmp_ge_i32 s8, 148
    s_cbranch_scc1 Lc_64
    s_waitcnt vmcnt(2)
Lc_64:
    s_waitcnt vmcnt(3)
Lc_65:
    s_waitcnt vmcnt(4)
    global_load_dwordx4 v[144:147], v1, s[4:5] offset:512 nt
    s_mov_b64 exec, 1
    ds_add_rtn_u32 v26, v24, v25 offset:48
    s_mov_b64 exec, -1
    s_waitcnt lgkmcnt(0)
    v_readfirstlane_b32 s8, v26
    s_cmp_ge_i32 s8, 170
    s_cbranch_scc1 Lc_68
    s_cmp_ge_i32 s8, 156
    s_cbranch_scc1 Lc_67
    s_waitcnt vmcnt(2)
Lc_67:
    s_waitcnt vmcnt(3)
Lc_68:
    s_waitcnt vmcnt(4)
    global_load_dwordx4 v[148:151], v1, s[4:5] offset:768 nt
    s_add_u32 s4, s4, 32768
    s_addc_u32 s5, s5, 0
    s_mov_b64 exec, 1
    ds_add_rtn_u32 v26, v24, v25 offset:48
    s_mov_b64 exec, -1
    s_waitcnt lgkmcnt(0)
    v_readfirstlane_b32 s8, v26
    s_cmp_ge_i32 s8, 178
    s_cbranch_scc1 Lc_71
    s_cmp_ge_i32 s8, 164
    s_cbranch_scc1 Lc_70
    s_waitcnt vmcnt(2)
Lc_70:
    s_waitcnt vmcnt(3)
Lc_71:
    s_waitcnt vmcnt(4)
    global_load_dwordx4 v[152:155], v1, s[4:5] offset:0 nt
    s_mov_b64 exec, 1
    ds_add_rtn_u32 v26, v24, v25 offset:48
    s_mov_b64 exec, -1
    s_waitcnt lgkmcnt(0)
    v_readfirstlane_b32 s8, v26
    s_cmp_ge_i32 s8, 186
    s_cbranch_scc1 Lc_74
    s_cmp_ge_i32 s8, 172
    s_cbranch_scc1 Lc_73
    s_waitcnt vmcnt(2)
Lc_73:
    s_waitcnt vmcnt(3)
Lc_74:
    s_waitcnt vmcnt(4)
    global_load_dwordx4 v[156:159], v1, s[4:5] offset:256 nt
    s_mov_b64 exec, 1
    ds_add_rtn_u32 v26, v24, v25 offset:48
    s_mov_b64 exec, -1
    s_waitcnt lgkmcnt(0)
    v_readfirstlane_b32 s8, v26
    s_cmp_ge_i32 s8, 194
    s_cbranch_scc1 Lc_77
    s_cmp_ge_i32 s8, 180
    s_cbranch_scc1 Lc_76
    s_waitcnt vmcnt(2)
Lc_76:
    s_waitcnt vmcnt(3)
Lc_77:
    s_waitcnt vmcnt(4)
    global_load_dwordx4 v[160:163], v1, s[4:5] offset:512 nt
    s_mov_b64 exec, 1
    ds_add_rtn_u32 v26, v24, v25 offset:48
    s_mov_b64 exec, -1
    s_waitcnt lgkmcnt(0)
    v_readfirstlane_b32 s8, v26
    s_cmp_ge_i32 s8, 202
    s_cbranch_scc1 Lc_80
    s_cmp_ge_i32 s8, 188
    s_cbranch_scc1 Lc_79
    s_waitcnt vmcnt(2)
Lc_79:
    s_waitcnt vmcnt(3)
Lc_80:
    s_waitcnt vmcnt(4)
    global_load_dwordx4 v[164:167], v1, s[4:5] offset:768 nt
    s_mov_b64 exec, 1
    ds_add_rtn_u32 v26, v24, v25 offset:48
    s_mov_b64 exec, -1
    v_bfe_u32 v7, v0, 2, 2
    v_lshlrev_b32 v7, 4, v7
    v_lshrrev_b32 v3, 4, v0
    v_lshl_add_u32 v7, v3, 2, v7
    s_lshl_b32 s8, s3, 6
    s_add_u32 s8, s8, 4096
    v_add_u32 v7, s8, v7
    v_mov_b32 v3, 0
    s_mov_b32 s19, 16
    s_mov_b32 s18, 0
Llds_82:
    ds_read_b32 v4, v3 offset:12
    s_add_u32 s18, s18, 1
    s_cmp_gt_u32 s18, 400000
    s_cbranch_scc1 L_fail
    s_waitcnt lgkmcnt(0)
    v_readfirstlane_b32 s8, v4
    s_cmp_lt_u32 s8, 1
    s_cbranch_scc1 Llds_82
    v_lshrrev_b32 v3, 4, v0
    v_lshlrev_b32 v3, 2, v3
    v_and_b32 v4, 3, v0
    v_add_u32 v3, v3, v4
    v_lshlrev_b32 v3, 4, v3
    v_add_u32 v3, 256, v3
    v_bfe_u32 v4, v0, 2, 2
    v_mov_b32 v5, 512
    v_cmp_eq_u32 vcc, 0, v4
    s_nop 1
    v_cndmask_b32 v6, v5, v3, vcc
    ds_read_b128 v[8:11], v6
    v_cmp_eq_u32 vcc, 1, v4
    s_nop 1
    v_cndmask_b32 v6, v5, v3, vcc
    ds_read_b128 v[12:15], v6
    v_cmp_eq_u32 vcc, 2, v4
    s_nop 1
    v_cndmask_b32 v6, v5, v3, vcc
    ds_read_b128 v[16:19], v6
    v_cmp_eq_u32 vcc, 3, v4
    s_nop 1
    v_cndmask_b32 v6, v5, v3, vcc
    ds_read_b128 v[20:23], v6
    s_waitcnt lgkmcnt(0)
    v_mfma_f32_16x16x32_bf16 v[32:35], v[8:11], v[40:43], 0
    v_mfma_f32_16x16x32_bf16 v[32:35], v[12:15], v[44:47], v[32:35]
    v_mfma_f32_16x16x32_bf16 v[32:35], v[16:19], v[48:51], v[32:35]
    v_mfma_f32_16x16x32_bf16 v[32:35], v[20:23], v[52:55], v[32:35]
    s_nop 7
    v_mov_b32_dpp v24, v32 quad_perm:[0,0,0,0] row_mask:0xf bank_mask:0xf
    s_nop 1
    v_add_f32_dpp v24, v33, v24 quad_perm:[1,1,1,1] row_mask:0xf bank_mask:0xf
    s_nop 1
    v_add_f32_dpp v24, v34, v24 quad_perm:[2,2,2,2] row_mask:0xf bank_mask:0xf
    s_nop 1
    v_add_f32_dpp v24, v35, v24 quad_perm:[3,3,3,3] row_mask:0xf bank_mask:0xf
    v_cvt_pk_bf16_f32 v24, v24, v24
    v_and_b32 v24, 0xffff0000, v24
    v_mul_f32 v24, 0x3db504f3, v24
    v_cvt_pk_bf16_f32 v24, v24, v24
    v_and_b32 v24, 0xffff0000, v24
    global_load_dwordx4 v[40:43], v2, s[6:7] offset:0 nt
    global_load_dwordx4 v[44:47], v2, s[6:7] offset:1024 nt
    global_load_dwordx4 v[48:51], v2, s[6:7] offset:2048 nt
    global_load_dwordx4 v[52:55], v2, s[6:7] offset:3072 nt
    s_add_u32 s6, s6, 32768
    s_addc_u32 s7, s7, 0
    s_waitcnt vmcnt(4)
    v_mfma_f32_16x16x32_bf16 v[36:39], v[8:11], v[56:59], 0
    v_mfma_f32_16x16x32_bf16 v[36:39], v[12:15], v[60:63], v[36:39]
    v_mfma_f32_16x16x32_bf16 v[36:39], v[16:19], v[64:67], v[36:39]
    v_mfma_f32_16x16x32_bf16 v[36:39], v[20:23], v[68:71], v[36:39]
    s_nop 7
    v_mov_b32_dpp v25, v36 quad_perm:[0,0,0,0] row_mask:0xf bank_mask:0xf
    s_nop 1
    v_add_f32_dpp v25, v37, v25 quad_perm:[1,1,1,1] row_mask:0xf bank_mask:0xf
    s_nop 1
    v_add_f32_dpp v25, v38, v25 quad_perm:[2,2,2,2] row_mask:0xf bank_mask:0xf
    s_nop 1
    v_add_f32_dpp v25, v39, v25 quad_perm:[3,3,3,3] row_mask:0xf bank_mask:0xf
    v_cvt_pk_bf16_f32 v25, v25, v25
    v_and_b32 v25, 0xffff0000, v25
    v_mul_f32 v25, 0x3db504f3, v25
    v_cvt_pk_bf16_f32 v25, v25, v25
    v_and_b32 v25, 0xffff0000, v25
    v_mfma_f32_16x16x32_bf16 v[32:35], v[8:11], v[72:75], 0
    v_mfma_f32_16x16x32_bf16 v[32:35], v[12:15], v[76:79], v[32:35]
    v_mfma_f32_16x16x32_bf16 v[32:35], v[16:19], v[80:83], v[32:35]
    v_mfma_f32_16x16x32_bf16 v[32:35], v[20:23], v[84:87], v[32:35]
    s_nop 7
    v_mov_b32_dpp v26, v32 quad_perm:[0,0,0,0] row_mask:0xf bank_mask:0xf
    s_nop 1
    v_add_f32_dpp v26, v33, v26 quad_perm:[1,1,1,1] row_mask:0xf bank_mask:0xf
    s_nop 1
    v_add_f32_dpp v26, v34, v26 quad_perm:[2,2,2,2] row_mask:0xf bank_mask:0xf
    s_nop 1
    v_add_f32_dpp v26, v35, v26 quad_perm:[3,3,3,3] row_mask:0xf bank_mask:0xf
    v_cvt_pk_bf16_f32 v26, v26, v26
    v_and_b32 v26, 0xffff0000, v26
    v_mul_f32 v26, 0x3db504f3, v26
    v_cvt_pk_bf16_f32 v26, v26, v26
    v_and_b32 v26, 0xffff0000, v26
    v_mfma_f32_16x16x32_bf16 v[36:39], v[8:11], v[88:91], 0
    v_mfma_f32_16x16x32_bf16 v[36:39], v[12:15], v[92:95], v[36:39]
    v_mfma_f32_16x16x32_bf16 v[36:39], v[16:19], v[96:99], v[36:39]
    v_mfma_f32_16x16x32_bf16 v[36:39], v[20:23], v[100:103], v[36:39]
    s_nop 7
    v_mov_b32_dpp v27, v36 quad_perm:[0,0,0,0] row_mask:0xf bank_mask:0xf
    s_nop 1
    v_add_f32_dpp v27, v37, v27 quad_perm:[1,1,1,1] row_mask:0xf bank_mask:0xf
    s_nop 1
    v_add_f32_dpp v27, v38, v27 quad_perm:[2,2,2,2] row_mask:0xf bank_mask:0xf
    s_nop 1
    v_add_f32_dpp v27, v39, v27 quad_perm:[3,3,3,3] row_mask:0xf bank_mask:0xf
    v_cvt_pk_bf16_f32 v27, v27, v27
    v_and_b32 v27, 0xffff0000, v27
    v_mul_f32 v27, 0x3db504f3, v27
    v_cvt_pk_bf16_f32 v27, v27, v27
    v_and_b32 v27, 0xffff0000, v27
    v_mfma_f32_16x16x32_bf16 v[32:35], v[8:11], v[104:107], 0
    v_mfma_f32_16x16x32_bf16 v[32:35], v[12:15], v[108:111], v[32:35]
    v_mfma_f32_16x16x32_bf16 v[32:35], v[16:19], v[112:115], v[32:35]
    v_mfma_f32_16x16x32_bf16 v[32:35], v[20:23], v[116:119], v[32:35]
    s_nop 7
    v_mov_b32_dpp v28, v32 quad_perm:[0,0,0,0] row_mask:0xf bank_mask:0xf
    s_nop 1
    v_add_f32_dpp v28, v33, v28 quad_perm:[1,1,1,1] row_mask:0xf bank_mask:0xf
    s_nop 1
    v_add_f32_dpp v28, v34, v28 quad_perm:[2,2,2,2] row_mask:0xf bank_mask:0xf
    s_nop 1
    v_add_f32_dpp v28, v35, v28 quad_perm:[3,3,3,3] row_mask:0xf bank_mask:0xf
    v_cvt_pk_bf16_f32 v28, v28, v28
    v_and_b32 v28, 0xffff0000, v28
    v_mul_f32 v28, 0x3db504f3, v28
    v_cvt_pk_bf16_f32 v28, v28, v28
    v_and_b32 v28, 0xffff0000, v28
    v_mfma_f32_16x16x32_bf16 v[36:39], v[8:11], v[120:123], 0
    v_mfma_f32_16x16x32_bf16 v[36:39], v[12:15], v[124:127], v[36:39]
    v_mfma_f32_16x16x32_bf16 v[36:39], v[16:19], v[128:131], v[36:39]
    v_mfma_f32_16x16x32_bf16 v[36:39], v[20:23], v[132:135], v[36:39]
    s_nop 7
    v_mov_b32_dpp v29, v36 quad_perm:[0,0,0,0] row_mask:0xf bank_mask:0xf
    s_nop 1
    v_add_f32_dpp v29, v37, v29 quad_perm:[1,1,1,1] row_mask:0xf bank_mask:0xf
    s_nop 1
    v_add_f32_dpp v29, v38, v29 quad_perm:[2,2,2,2] row_mask:0xf bank_mask:0xf
    s_nop 1
    v_add_f32_dpp v29, v39, v29 quad_perm:[3,3,3,3] row_mask:0xf bank_mask:0xf
    v_cvt_pk_bf16_f32 v29, v29, v29
    v_and_b32 v29, 0xffff0000, v29
    v_mul_f32 v29, 0x3db504f3, v29
    v_cvt_pk_bf16_f32 v29, v29, v29
    v_and_b32 v29, 0xffff0000, v29
    v_mfma_f32_16x16x32_bf16 v[32:35], v[8:11], v[136:139], 0
    v_mfma_f32_16x16x32_bf16 v[32:35], v[12:15], v[140:143], v[32:35]
    v_mfma_f32_16x16x32_bf16 v[32:35], v[16:19], v[144:147], v[32:35]
    v_mfma_f32_16x16x32_bf16 v[32:35], v[20:23], v[148:151], v[32:35]
    s_nop 7
    v_mov_b32_dpp v30, v32 quad_perm:[0,0,0,0] row_mask:0xf bank_mask:0xf
    s_nop 1
    v_add_f32_dpp v30, v33, v30 quad_perm:[1,1,1,1] row_mask:0xf bank_mask:0xf
    s_nop 1
    v_add_f32_dpp v30, v34, v30 quad_perm:[2,2,2,2] row_mask:0xf bank_mask:0xf
    s_nop 1
    v_add_f32_dpp v30, v35, v30 quad_perm:[3,3,3,3] row_mask:0xf bank_mask:0xf
    v_cvt_pk_bf16_f32 v30, v30, v30
    v_and_b32 v30, 0xffff0000, v30
    v_mul_f32 v30, 0x3db504f3, v30
    v_cvt_pk_bf16_f32 v30, v30, v30
    v_and_b32 v30, 0xffff0000, v30
    v_mfma_f32_16x16x32_bf16 v[36:39], v[8:11], v[152:155], 0
    v_mfma_f32_16x16x32_bf16 v[36:39], v[12:15], v[156:159], v[36:39]
    v_mfma_f32_16x16x32_bf16 v[36:39], v[16:19], v[160:163], v[36:39]
    v_mfma_f32_16x16x32_bf16 v[36:39], v[20:23], v[164:167], v[36:39]
    s_nop 7
    v_mov_b32_dpp v31, v36 quad_perm:[0,0,0,0] row_mask:0xf bank_mask:0xf
    s_nop 1
    v_add_f32_dpp v31, v37, v31 quad_perm:[1,1,1,1] row_mask:0xf bank_mask:0xf
    s_nop 1
    v_add_f32_dpp v31, v38, v31 quad_perm:[2,2,2,2] row_mask:0xf bank_mask:0xf
    s_nop 1
    v_add_f32_dpp v31, v39, v31 quad_perm:[3,3,3,3] row_mask:0xf bank_mask:0xf
    v_cvt_pk_bf16_f32 v31, v31, v31
    v_and_b32 v31, 0xffff0000, v31
    v_mul_f32 v31, 0x3db504f3, v31
    v_cvt_pk_bf16_f32 v31, v31, v31
    v_and_b32 v31, 0xffff0000, v31
    s_mov_b32 exec_lo, 0x11111111
    s_mov_b32 exec_hi, 0x11111111
    ds_write_b32 v7, v31
    s_mov_b64 exec, -1
    v_max3_f32 v4, v24, v25, v26
    v_max3_f32 v4, v4, v27, v28
    v_max3_f32 v4, v4, v29, v30
    v_max_f32 v4, v4, v31
    s_nop 1
    v_max_f32_dpp v4, v4, v4 row_ror:4 row_mask:0xf bank_mask:0xf
    s_nop 1
    v_max_f32_dpp v4, v4, v4 row_ror:8 row_mask:0xf bank_mask:0xf
    v_mov_b32 v3, v4
    s_nop 1
    v_permlane16_swap_b32 v4, v3
    v_max_f32 v4, v4, v3
    v_mov_b32 v3, v4
    s_nop 1
    v_permlane32_swap_b32 v4, v3
    v_max_f32 v4, v4, v3
    v_sub_f32 v24, v24, v4
    v_sub_f32 v25, v25, v4
    v_sub_f32 v26, v26, v4
    v_sub_f32 v27, v27, v4
    v_sub_f32 v28, v28, v4
    v_sub_f32 v29, v29, v4
    v_sub_f32 v30, v30, v4
    v_sub_f32 v31, v31, v4
    v_mul_f32 v24, 0x3fb8aa3b, v24
    v_mul_f32 v25, 0x3fb8aa3b, v25
    v_mul_f32 v26, 0x3fb8aa3b, v26
    v_mul_f32 v27, 0x3fb8aa3b, v27
    v_mul_f32 v28, 0x3fb8aa3b, v28
    v_mul_f32 v29, 0x3fb8aa3b, v29
    v_mul_f32 v30, 0x3fb8aa3b, v30
    v_mul_f32 v31, 0x3fb8aa3b, v31
    v_exp_f32 v24, v24
    v_exp_f32 v25, v25
    v_exp_f32 v26, v26
    v_exp_f32 v27, v27
    v_exp_f32 v28, v28
    v_exp_f32 v29, v29
    v_exp_f32 v30, v30
    v_exp_f32 v31, v31
    v_add_f32 v5, v24, v25
    v_add_f32 v5, v5, v26
    v_add_f32 v5, v5, v27
    v_add_f32 v5, v5, v28
    v_add_f32 v5, v5, v29
    v_add_f32 v5, v5, v30
    v_add_f32 v5, v5, v31
    s_nop 1
    v_add_f32_dpp v5, v5, v5 row_ror:4 row_mask:0xf bank_mask:0xf
    s_nop 1
    v_add_f32_dpp v5, v5, v5 row_ror:8 row_mask:0xf bank_mask:0xf
    v_mov_b32 v3, v5
    s_nop 1
    v_permlane16_swap_b32 v5, v3
    v_add_f32 v5, v5, v3
    v_mov_b32 v3, v5
    s_nop 1
    v_permlane32_swap_b32 v5, v3
    v_add_f32 v5, v5, v3
    s_lshl_b32 s8, s3, 3
    v_mov_b32 v3, s8
    ds_write_b64 v3, v[4:5] offset:64
    v_and_b32 v6, 7, v0
    v_and_b32 v7, 1, v6
    v_cmp_eq_u32 vcc, 1, v7
    v_mov_b32 v7, 0xffff
    v_mov_b32 v3, 0xffff0000
    v_cndmask_b32 v7, v7, v3, vcc
    v_lshrrev_b32 v6, 1, v6
    v_cmp_eq_u32 vcc, 0, v6
    s_nop 1
    v_cndmask_b32 v8, 0, v7, vcc
    v_cmp_eq_u32 vcc, 1, v6
    s_nop 1
    v_cndmask_b32 v9, 0, v7, vcc
    v_cmp_eq_u32 vcc, 2, v6
    s_nop 1
    v_cndmask_b32 v10, 0, v7, vcc
    v_cmp_eq_u32 vcc, 3, v6
    s_nop 1
    v_cndmask_b32 v11, 0, v7, vcc
    s_mul_i32 s8, s34, 442368
    s_lshl_b32 s9, s36, 7
    s_add_u32 s8, s8, s9
    s_add_u32 s28, s28, s8
    s_addc_u32 s29, s29, 0
    s_add_u32 s30, s30, s8
    s_addc_u32 s31, s31, 0
    s_mul_i32 s8, s36, 81920
    s_lshl_b32 s9, s34, 8
    s_add_u32 s8, s8, s9
    s_add_u32 s32, s32, s8
    s_addc_u32 s33, s33, 0
    s_cmp_le_u32 s50, 36
    s_cbranch_scc1 Lthr_83
    s_cmp_le_u32 s51, 36
    s_cbranch_scc1 Lthr_84
    s_waitcnt vmcnt(1)
Lthr_84:
    s_waitcnt vmcnt(2)
Lthr_83:
    s_waitcnt vmcnt(3)
    global_load_dwordx4 v[56:59], v2, s[6:7] offset:0 nt
    v_mov_b32 v37, 0
    v_mov_b32 v38, 1
    s_mov_b64 exec, 1
    ds_add_rtn_u32 v39, v37, v38 offset:48
    s_mov_b64 exec, -1
    s_waitcnt lgkmcnt(0)
    v_readfirstlane_b32 s8, v39
    s_cmp_ge_i32 s8, 218
    s_cbranch_scc1 Lc_86
    s_cmp_ge_i32 s8, 204
    s_cbranch_scc1 Lc_85
    s_waitcnt vmcnt(2)
Lc_85:
    s_waitcnt vmcnt(3)
Lc_86:
    s_waitcnt vmcnt(4)
    global_load_dwordx4 v[60:63], v2, s[6:7] offset:1024 nt
    s_mov_b64 exec, 1
    ds_add_rtn_u32 v39, v37, v38 offset:48
    s_mov_b64 exec, -1
    s_waitcnt lgkmcnt(0)
    v_readfirstlane_b32 s8, v39
    s_cmp_ge_i32 s8, 226
    s_cbranch_scc1 Lc_89
    s_cmp_ge_i32 s8, 212
    s_cbranch_scc1 Lc_88
    s_waitcnt vmcnt(2)
Lc_88:
    s_waitcnt vmcnt(3)
Lc_89:
    s_waitcnt vmcnt(4)
    global_load_dwordx4 v[64:67], v2, s[6:7] offset:2048 nt
    s_mov_b64 exec, 1
    ds_add_rtn_u32 v39, v37, v38 offset:48
    s_mov_b64 exec, -1
    s_waitcnt lgkmcnt(0)
    v_readfirstlane_b32 s8, v39
    s_cmp_ge_i32 s8, 234
    s_cbranch_scc1 Lc_92
    s_cmp_ge_i32 s8, 220
    s_cbranch_scc1 Lc_91
    s_waitcnt vmcnt(2)
Lc_91:
    s_waitcnt vmcnt(3)
Lc_92:
    s_waitcnt vmcnt(4)
    global_load_dwordx4 v[68:71], v2, s[6:7] offset:3072 nt
    s_add_u32 s6, s6, 32768
    s_addc_u32 s7, s7, 0
    s_mov_b64 exec, 1
    ds_add_rtn_u32 v39, v37, v38 offset:48
    s_mov_b64 exec, -1
    s_waitcnt lgkmcnt(0)
    v_readfirstlane_b32 s8, v39
    s_cmp_ge_i32 s8, 242
    s_cbranch_scc1 Lc_95
    s_cmp_ge_i32 s8, 228
    s_cbranch_scc1 Lc_94
    s_waitcnt vmcnt(2)
Lc_94:
    s_waitcnt vmcnt(3)
Lc_95:
    s_waitcnt vmcnt(4)
    global_load_dwordx4 v[72:75], v2, s[6:7] offset:0 nt
    s_mov_b64 exec, 1
    ds_add_rtn_u32 v39, v37, v38 offset:48
    s_mov_b64 exec, -1
    s_waitcnt lgkmcnt(0)
    v_readfirstlane_b32 s8, v39
    s_cmp_ge_i32 s8, 250
    s_cbranch_scc1 Lc_98
    s_cmp_ge_i32 s8, 236
    s_cbranch_scc1 Lc_97
    s_waitcnt vmcnt(2)
Lc_97:
    s_waitcnt vmcnt(3)
Lc_98:
    s_waitcnt vmcnt(4)
    global_load_dwordx4 v[76:79], v2, s[6:7] offset:1024 nt
    s_mov_b64 exec, 1
    ds_add_rtn_u32 v39, v37, v38 offset:48
    s_mov_b64 exec, -1
    s_waitcnt lgkmcnt(0)
    v_readfirstlane_b32 s8, v39
    s_cmp_ge_i32 s8, 258
    s_cbranch_scc1 Lc_101
    s_cmp_ge_i32 s8, 244
    s_cbranch_scc1 Lc_100
    s_waitcnt vmcnt(2)
Lc_100:
    s_waitcnt vmcnt(3)
Lc_101:
    s_waitcnt vmcnt(4)
    global_load_dwordx4 v[80:83], v2, s[6:7] offset:2048 nt
    s_mov_b64 exec, 1
    ds_add_rtn_u32 v39, v37, v38 offset:48
    s_mov_b64 exec, -1
    s_waitcnt lgkmcnt(0)
    v_readfirstlane_b32 s8, v39
    s_cmp_ge_i32 s8, 266
    s_cbranch_scc1 Lc_104
    s_cmp_ge_i32 s8, 252
    s_cbranch_scc1 Lc_103
    s_waitcnt vmcnt(2)
Lc_103:
    s_waitcnt vmcnt(3)
Lc_104:
    s_waitcnt vmcnt(4)
    global_load_dwordx4 v[84:87], v2, s[6:7] offset:3072 nt
    s_add_u32 s6, s6, 32768
    s_addc_u32 s7, s7, 0
    s_mov_b64 exec, 1
    ds_add_rtn_u32 v39, v37, v38 offset:48
    s_mov_b64 exec, -1
    s_waitcnt lgkmcnt(0)
    v_readfirstlane_b32 s8, v39
    s_cmp_ge_i32 s8, 274
    s_cbranch_scc1 Lc_107
    s_cmp_ge_i32 s8, 260
    s_cbranch_scc1 Lc_106
    s_waitcnt vmcnt(2)
Lc_106:
    s_waitcnt vmcnt(3)
Lc_107:
    s_waitcnt vmcnt(4)
    global_load_dwordx4 v[88:91], v2, s[6:7] offset:0 nt
    s_mov_b64 exec, 1
    ds_add_rtn_u32 v39, v37, v38 offset:48
    s_mov_b64 exec, -1
    s_waitcnt lgkmcnt(0)
    v_readfirstlane_b32 s8, v39
    s_cmp_ge_i32 s8, 282
    s_cbranch_scc1 Lc_110
    s_cmp_ge_i32 s8, 268
    s_cbranch_scc1 Lc_109
    s_waitcnt vmcnt(2)
Lc_109:
    s_waitcnt vmcnt(3)
Lc_110:
    s_waitcnt vmcnt(4)
    global_load_dwordx4 v[92:95], v2, s[6:7] offset:1024 nt
    s_mov_b64 exec, 1
    ds_add_rtn_u32 v39, v37, v38 offset:48
    s_mov_b64 exec, -1
    s_waitcnt lgkmcnt(0)
    v_readfirstlane_b32 s8, v39
    s_cmp_ge_i32 s8, 290
    s_cbranch_scc1 Lc_113
    s_cmp_ge_i32 s8, 276
    s_cbranch_scc1 Lc_112
    s_waitcnt vmcnt(2)
Lc_112:
    s_waitcnt vmcnt(3)
Lc_113:
    s_waitcnt vmcnt(4)
    global_load_dwordx4 v[96:99], v2, s[6:7] offset:2048 nt
    s_mov_b64 exec, 1
    ds_add_rtn_u32 v39, v37, v38 offset:48
    s_mov_b64 exec, -1
    s_waitcnt lgkmcnt(0)
    v_readfirstlane_b32 s8, v39
    s_cmp_ge_i32 s8, 298
    s_cbranch_scc1 Lc_116
    s_cmp_ge_i32 s8, 284
    s_cbranch_scc1 Lc_115
    s_waitcnt vmcnt(2)
Lc_115:
    s_waitcnt vmcnt(3)
Lc_116:
    s_waitcnt vmcnt(4)
    global_load_dwordx4 v[100:103], v2, s[6:7] offset:3072 nt
    s_add_u32 s6, s6, 32768
    s_addc_u32 s7, s7, 0
    s_mov_b64 exec, 1
    ds_add_rtn_u32 v39, v37, v38 offset:48
    s_mov_b64 exec, -1
    s_waitcnt lgkmcnt(0)
    v_readfirstlane_b32 s8, v39
    s_cmp_ge_i32 s8, 306
    s_cbranch_scc1 Lc_119
    s_cmp_ge_i32 s8, 292
    s_cbranch_scc1 Lc_118
    s_waitcnt vmcnt(2)
Lc_118:
    s_waitcnt vmcnt(3)
Lc_119:
    s_waitcnt vmcnt(4)
    global_load_dwordx4 v[104:107], v2, s[6:7] offset:0 nt
    s_mov_b64 exec, 1
    ds_add_rtn_u32 v39, v37, v38 offset:48
    s_mov_b64 exec, -1
    s_waitcnt lgkmcnt(0)
    v_readfirstlane_b32 s8, v39
    s_cmp_ge_i32 s8, 314
    s_cbranch_scc1 Lc_122
    s_cmp_ge_i32 s8, 300
    s_cbranch_scc1 Lc_121
    s_waitcnt vmcnt(2)
Lc_121:
    s_waitcnt vmcnt(3)
Lc_122:
    s_waitcnt vmcnt(4)
    global_load_dwordx4 v[108:111], v2, s[6:7] offset:1024 nt
    s_mov_b64 exec, 1
    ds_add_rtn_u32 v39, v37, v38 offset:48
    s_mov_b64 exec, -1
    s_waitcnt lgkmcnt(0)
    v_readfirstlane_b32 s8, v39
    s_cmp_ge_i32 s8, 322
    s_cbranch_scc1 Lc_125
    s_cmp_ge_i32 s8, 308
    s_cbranch_scc1 Lc_124
    s_waitcnt vmcnt(2)
Lc_124:
    s_waitcnt vmcnt(3)
Lc_125:
    s_waitcnt vmcnt(4)
    global_load_dwordx4 v[112:115], v2, s[6:7] offset:2048 nt
    s_mov_b64 exec, 1
    ds_add_rtn_u32 v39, v37, v38 offset:48
    s_mov_b64 exec, -1
    v_mov_b32 v3, 0
    v_mov_b32 v6, 1
    s_mov_b64 s[16:17], exec
    s_mov_b64 exec, 1
    ds_add_u32 v3, v6 offset:40
    s_mov_b64 exec, s[16:17]
    s_waitcnt lgkmcnt(0)
    v_readfirstlane_b32 s8, v39
    s_cmp_ge_i32 s8, 330
    s_cbranch_scc1 Lc_128
    s_cmp_ge_i32 s8, 316
    s_cbranch_scc1 Lc_127
    s_waitcnt vmcnt(2)
Lc_127:
    s_waitcnt vmcnt(3)
Lc_128:
    s_waitcnt vmcnt(4)
    global_load_dwordx4 v[116:119], v2, s[6:7] offset:3072 nt
    s_add_u32 s6, s6, 32768
    s_addc_u32 s7, s7, 0
    s_mov_b64 exec, 1
    ds_add_rtn_u32 v39, v37, v38 offset:48
    s_mov_b64 exec, -1
    s_waitcnt lgkmcnt(0)
    v_readfirstlane_b32 s8, v39
    s_cmp_ge_i32 s8, 338
    s_cbranch_scc1 Lc_131
    s_cmp_ge_i32 s8, 324
    s_cbranch_scc1 Lc_130
    s_waitcnt vmcnt(2)
Lc_130:
    s_waitcnt vmcnt(3)
Lc_131:
    s_waitcnt vmcnt(4)
    global_load_dwordx4 v[120:123], v2, s[6:7] offset:0 nt
    s_mov_b64 exec, 1
    ds_add_rtn_u32 v39, v37, v38 offset:48
    s_mov_b64 exec, -1
    v_mov_b32 v3, 0
    s_mov_b32 s19, 0x11
    s_mov_b32 s18, 0
Lp_133:
    ds_read_b64 v[6:7], v3 offset:128
    s_add_u32 s18, s18, 1
    s_cmp_gt_u32 s18, 400000
    s_cbranch_scc1 L_fail
    s_waitcnt lgkmcnt(0)
    v_cmp_eq_u32 vcc, -1, v7
    s_cbranch_vccnz Lp_133
    v_sub_f32 v6, v4, v6
    v_mul_f32 v6, 0x3fb8aa3b, v6
    v_exp_f32 v6, v6
    s_nop 0
    v_mul_f32 v6, v6, v7
    v_mul_f32 v24, v24, v6
    v_mul_f32 v25, v25, v6
    v_mul_f32 v26, v26, v6
    v_mul_f32 v27, v27, v6
    v_mul_f32 v28, v28, v6
    v_mul_f32 v29, v29, v6
    v_mul_f32 v30, v30, v6
    v_mul_f32 v31, v31, v6
    v_cvt_pk_bf16_f32 v24, v24, v24
    v_cvt_pk_bf16_f32 v25, v25, v25
    v_cvt_pk_bf16_f32 v26, v26, v26
    v_cvt_pk_bf16_f32 v27, v27, v27
    v_cvt_pk_bf16_f32 v28, v28, v28
    v_cvt_pk_bf16_f32 v29, v29, v29
    v_cvt_pk_bf16_f32 v30, v30, v30
    v_cvt_pk_bf16_f32 v31, v31, v31
    v_and_b32_dpp v12, v24, v8 row_newbcast:0 row_mask:0xf bank_mask:0xf
    v_and_b32_dpp v13, v24, v9 row_newbcast:0 row_mask:0xf bank_mask:0xf
    v_and_b32_dpp v14, v24, v10 row_newbcast:0 row_mask:0xf bank_mask:0xf
    v_and_b32_dpp v15, v24, v11 row_newbcast:0 row_mask:0xf bank_mask:0xf
    s_nop 1
    v_mfma_f32_16x16x32_bf16 v[20:23], v[40:43], v[12:15], 0
    v_and_b32_dpp v16, v24, v8 row_newbcast:4 row_mask:0xf bank_mask:0xf
    v_and_b32_dpp v17, v24, v9 row_newbcast:4 row_mask:0xf bank_mask:0xf
    v_and_b32_dpp v18, v24, v10 row_newbcast:4 row_mask:0xf bank_mask:0xf
    v_and_b32_dpp v19, v24, v11 row_newbcast:4 row_mask:0xf bank_mask:0xf
    s_nop 1
    v_mfma_f32_16x16x32_bf16 v[20:23], v[44:47], v[16:19], v[20:23]
    v_and_b32_dpp v12, v24, v8 row_newbcast:8 row_mask:0xf bank_mask:0xf
    v_and_b32_dpp v13, v24, v9 row_newbcast:8 row_mask:0xf bank_mask:0xf
    v_and_b32_dpp v14, v24, v10 row_newbcast:8 row_mask:0xf bank_mask:0xf
    v_and_b32_dpp v15, v24, v11 row_newbcast:8 row_mask:0xf bank_mask:0xf
    s_nop 1
    v_mfma_f32_16x16x32_bf16 v[20:23], v[48:51], v[12:15], v[20:23]
    v_and_b32_dpp v16, v24, v8 row_newbcast:12 row_mask:0xf bank_mask:0xf
    v_and_b32_dpp v17, v24, v9 row_newbcast:12 row_mask:0xf bank_mask:0xf
    v_and_b32_dpp v18, v24, v10 row_newbcast:12 row_mask:0xf bank_mask:0xf
    v_and_b32_dpp v19, v24, v11 row_newbcast:12 row_mask:0xf bank_mask:0xf
    s_nop 1
    v_mfma_f32_16x16x32_bf16 v[20:23], v[52:55], v[16:19], v[20:23]
    s_waitcnt lgkmcnt(0)
    v_readfirstlane_b32 s8, v39
    s_cmp_ge_i32 s8, 346
    s_cbranch_scc1 Lc_135
    s_cmp_ge_i32 s8, 332
    s_cbranch_scc1 Lc_134
    s_waitcnt vmcnt(2)
Lc_134:
    s_waitcnt vmcnt(3)
Lc_135:
    s_waitcnt vmcnt(4)
    global_load_dwordx4 v[124:127], v2, s[6:7] offset:1024 nt
    s_mov_b64 exec, 1
    ds_add_rtn_u32 v39, v37, v38 offset:48
    s_mov_b64 exec, -1
    v_and_b32_dpp v12, v25, v8 row_newbcast:0 row_mask:0xf bank_mask:0xf
    v_and_b32_dpp v13, v25, v9 row_newbcast:0 row_mask:0xf bank_mask:0xf
    v_and_b32_dpp v14, v25, v10 row_newbcast:0 row_mask:0xf bank_mask:0xf
    v_and_b32_dpp v15, v25, v11 row_newbcast:0 row_mask:0xf bank_mask:0xf
    s_nop 1
    v_mfma_f32_16x16x32_bf16 v[20:23], v[56:59], v[12:15], v[20:23]
    v_and_b32_dpp v16, v25, v8 row_newbcast:4 row_mask:0xf bank_mask:0xf
    v_and_b32_dpp v17, v25, v9 row_newbcast:4 row_mask:0xf bank_mask:0xf
    v_and_b32_dpp v18, v25, v10 row_newbcast:4 row_mask:0xf bank_mask:0xf
    v_and_b32_dpp v19, v25, v11 row_newbcast:4 row_mask:0xf bank_mask:0xf
    s_nop 1
    v_mfma_f32_16x16x32_bf16 v[20:23], v[60:63], v[16:19], v[20:23]
    v_and_b32_dpp v12, v25, v8 row_newbcast:8 row_mask:0xf bank_mask:0xf
    v_and_b32_dpp v13, v25, v9 row_newbcast:8 row_mask:0xf bank_mask:0xf
    v_and_b32_dpp v14, v25, v10 row_newbcast:8 row_mask:0xf bank_mask:0xf
    v_and_b32_dpp v15, v25, v11 row_newbcast:8 row_mask:0xf bank_mask:0xf
    s_nop 1
    v_mfma_f32_16x16x32_bf16 v[20:23], v[64:67], v[12:15], v[20:23]
    v_and_b32_dpp v16, v25, v8 row_newbcast:12 row_mask:0xf bank_mask:0xf
    v_and_b32_dpp v17, v25, v9 row_newbcast:12 row_mask:0xf bank_mask:0xf
    v_and_b32_dpp v18, v25, v10 row_newbcast:12 row_mask:0xf bank_mask:0xf
    v_and_b32_dpp v19, v25, v11 row_newbcast:12 row_mask:0xf bank_mask:0xf
    s_nop 1
    v_mfma_f32_16x16x32_bf16 v[20:23], v[68:71], v[16:19], v[20:23]
    s_waitcnt lgkmcnt(0)
    v_readfirstlane_b32 s8, v39
    s_cmp_ge_i32 s8, 354
    s_cbranch_scc1 Lc_138
    s_cmp_ge_i32 s8, 340
    s_cbranch_scc1 Lc_137
    s_waitcnt vmcnt(2)
Lc_137:
    s_waitcnt vmcnt(3)
Lc_138:
    s_waitcnt vmcnt(4)
    global_load_dwordx4 v[128:131], v2, s[6:7] offset:2048 nt
    s_mov_b64 exec, 1
    ds_add_rtn_u32 v39, v37, v38 offset:48
    s_mov_b64 exec, -1
    v_and_b32_dpp v12, v26, v8 row_newbcast:0 row_mask:0xf bank_mask:0xf
    v_and_b32_dpp v13, v26, v9 row_newbcast:0 row_mask:0xf bank_mask:0xf
    v_and_b32_dpp v14, v26, v10 row_newbcast:0 row_mask:0xf bank_mask:0xf
    v_and_b32_dpp v15, v26, v11 row_newbcast:0 row_mask:0xf bank_mask:0xf
    s_nop 1
    v_mfma_f32_16x16x32_bf16 v[20:23], v[72:75], v[12:15], v[20:23]
    v_and_b32_dpp v16, v26, v8 row_newbcast:4 row_mask:0xf bank_mask:0xf
    v_and_b32_dpp v17, v26, v9 row_newbcast:4 row_mask:0xf bank_mask:0xf
    v_and_b32_dpp v18, v26, v10 row_newbcast:4 row_mask:0xf bank_mask:0xf
    v_and_b32_dpp v19, v26, v11 row_newbcast:4 row_mask:0xf bank_mask:0xf
    s_nop 1
    v_mfma_f32_16x16x32_bf16 v[20:23], v[76:79], v[16:19], v[20:23]
    v_and_b32_dpp v12, v26, v8 row_newbcast:8 row_mask:0xf bank_mask:0xf
    v_and_b32_dpp v13, v26, v9 row_newbcast:8 row_mask:0xf bank_mask:0xf
    v_and_b32_dpp v14, v26, v10 row_newbcast:8 row_mask:0xf bank_mask:0xf
    v_and_b32_dpp v15, v26, v11 row_newbcast:8 row_mask:0xf bank_mask:0xf
    s_nop 1
    v_mfma_f32_16x16x32_bf16 v[20:23], v[80:83], v[12:15], v[20:23]
    v_and_b32_dpp v16, v26, v8 row_newbcast:12 row_mask:0xf bank_mask:0xf
    v_and_b32_dpp v17, v26, v9 row_newbcast:12 row_mask:0xf bank_mask:0xf
    v_and_b32_dpp v18, v26, v10 row_newbcast:12 row_mask:0xf bank_mask:0xf
    v_and_b32_dpp v19, v26, v11 row_newbcast:12 row_mask:0xf bank_mask:0xf
    s_nop 1
    v_mfma_f32_16x16x32_bf16 v[20:23], v[84:87], v[16:19], v[20:23]
    s_waitcnt lgkmcnt(0)
    v_readfirstlane_b32 s8, v39
    s_cmp_ge_i32 s8, 362
    s_cbranch_scc1 Lc_141
    s_cmp_ge_i32 s8, 348
    s_cbranch_scc1 Lc_140
    s_waitcnt vmcnt(2)
Lc_140:
    s_waitcnt vmcnt(3)
Lc_141:
    s_waitcnt vmcnt(4)
    global_load_dwordx4 v[132:135], v2, s[6:7] offset:3072 nt
    s_add_u32 s6, s6, 32768
    s_addc_u32 s7, s7, 0
    s_mov_b64 exec, 1
    ds_add_rtn_u32 v39, v37, v38 offset:48
    s_mov_b64 exec, -1
    v_and_b32_dpp v12, v27, v8 row_newbcast:0 row_mask:0xf bank_mask:0xf
    v_and_b32_dpp v13, v27, v9 row_newbcast:0 row_mask:0xf bank_mask:0xf
    v_and_b32_dpp v14, v27, v10 row_newbcast:0 row_mask:0xf bank_mask:0xf
    v_and_b32_dpp v15, v27, v11 row_newbcast:0 row_mask:0xf bank_mask:0xf
    s_nop 1
    v_mfma_f32_16x16x32_bf16 v[20:23], v[88:91], v[12:15], v[20:23]
    v_and_b32_dpp v16, v27, v8 row_newbcast:4 row_mask:0xf bank_mask:0xf
    v_and_b32_dpp v17, v27, v9 row_newbcast:4 row_mask:0xf bank_mask:0xf
    v_and_b32_dpp v18, v27, v10 row_newbcast:4 row_mask:0xf bank_mask:0xf
    v_and_b32_dpp v19, v27, v11 row_newbcast:4 row_mask:0xf bank_mask:0xf
    s_nop 1
    v_mfma_f32_16x16x32_bf16 v[20:23], v[92:95], v[16:19], v[20:23]
    v_and_b32_dpp v12, v27, v8 row_newbcast:8 row_mask:0xf bank_mask:0xf
    v_and_b32_dpp v13, v27, v9 row_newbcast:8 row_mask:0xf bank_mask:0xf
    v_and_b32_dpp v14, v27, v10 row_newbcast:8 row_mask:0xf bank_mask:0xf
    v_and_b32_dpp v15, v27, v11 row_newbcast:8 row_mask:0xf bank_mask:0xf
    s_nop 1
    v_mfma_f32_16x16x32_bf16 v[20:23], v[96:99], v[12:15], v[20:23]
    v_and_b32_dpp v16, v27, v8 row_newbcast:12 row_mask:0xf bank_mask:0xf
    v_and_b32_dpp v17, v27, v9 row_newbcast:12 row_mask:0xf bank_mask:0xf
    v_and_b32_dpp v18, v27, v10 row_newbcast:12 row_mask:0xf bank_mask:0xf
    v_and_b32_dpp v19, v27, v11 row_newbcast:12 row_mask:0xf bank_mask:0xf
    s_nop 1
    v_mfma_f32_16x16x32_bf16 v[20:23], v[100:103], v[16:19], v[20:23]
    s_waitcnt lgkmcnt(0)
    v_readfirstlane_b32 s8, v39
    s_cmp_ge_i32 s8, 370
    s_cbranch_scc1 Lc_144
    s_cmp_ge_i32 s8, 356
    s_cbranch_scc1 Lc_143
    s_waitcnt vmcnt(2)
Lc_143:
    s_waitcnt vmcnt(3)
Lc_144:
    s_waitcnt vmcnt(4)
    global_load_dwordx4 v[136:139], v2, s[6:7] offset:0 nt
    s_mov_b64 exec, 1
    ds_add_rtn_u32 v39, v37, v38 offset:48
    s_mov_b64 exec, -1
    v_and_b32_dpp v12, v28, v8 row_newbcast:0 row_mask:0xf bank_mask:0xf
    v_and_b32_dpp v13, v28, v9 row_newbcast:0 row_mask:0xf bank_mask:0xf
    v_and_b32_dpp v14, v28, v10 row_newbcast:0 row_mask:0xf bank_mask:0xf
    v_and_b32_dpp v15, v28, v11 row_newbcast:0 row_mask:0xf bank_mask:0xf
    s_nop 1
    v_mfma_f32_16x16x32_bf16 v[20:23], v[104:107], v[12:15], v[20:23]
    v_and_b32_dpp v16, v28, v8 row_newbcast:4 row_mask:0xf bank_mask:0xf
    v_and_b32_dpp v17, v28, v9 row_newbcast:4 row_mask:0xf bank_mask:0xf
    v_and_b32_dpp v18, v28, v10 row_newbcast:4 row_mask:0xf bank_mask:0xf
    v_and_b32_dpp v19, v28, v11 row_newbcast:4 row_mask:0xf bank_mask:0xf
    s_nop 1
    v_mfma_f32_16x16x32_bf16 v[20:23], v[108:111], v[16:19], v[20:23]
    v_and_b32_dpp v12, v28, v8 row_newbcast:8 row_mask:0xf bank_mask:0xf
    v_and_b32_dpp v13, v28, v9 row_newbcast:8 row_mask:0xf bank_mask:0xf
    v_and_b32_dpp v14, v28, v10 row_newbcast:8 row_mask:0xf bank_mask:0xf
    v_and_b32_dpp v15, v28, v11 row_newbcast:8 row_mask:0xf bank_mask:0xf
    s_nop 1
    v_mfma_f32_16x16x32_bf16 v[20:23], v[112:115], v[12:15], v[20:23]
    v_and_b32_dpp v16, v28, v8 row_newbcast:12 row_mask:0xf bank_mask:0xf
    v_and_b32_dpp v17, v28, v9 row_newbcast:12 row_mask:0xf bank_mask:0xf
    v_and_b32_dpp v18, v28, v10 row_newbcast:12 row_mask:0xf bank_mask:0xf
    v_and_b32_dpp v19, v28, v11 row_newbcast:12 row_mask:0xf bank_mask:0xf
    s_nop 1
    v_mfma_f32_16x16x32_bf16 v[20:23], v[116:119], v[16:19], v[20:23]
    s_waitcnt lgkmcnt(0)
    v_readfirstlane_b32 s8, v39
    s_cmp_ge_i32 s8, 378
    s_cbranch_scc1 Lc_147
    s_cmp_ge_i32 s8, 364
    s_cbranch_scc1 Lc_146
    s_waitcnt vmcnt(2)
Lc_146:
    s_waitcnt vmcnt(3)
Lc_147:
    s_waitcnt vmcnt(4)
    global_load_dwordx4 v[140:143], v2, s[6:7] offset:1024 nt
    s_mov_b64 exec, 1
    ds_add_rtn_u32 v39, v37, v38 offset:48
    s_mov_b64 exec, -1
    v_and_b32_dpp v12, v29, v8 row_newbcast:0 row_mask:0xf bank_mask:0xf
    v_and_b32_dpp v13, v29, v9 row_newbcast:0 row_mask:0xf bank_mask:0xf
    v_and_b32_dpp v14, v29, v10 row_newbcast:0 row_mask:0xf bank_mask:0xf
    v_and_b32_dpp v15, v29, v11 row_newbcast:0 row_mask:0xf bank_mask:0xf
    s_nop 1
    v_mfma_f32_16x16x32_bf16 v[20:23], v[120:123], v[12:15], v[20:23]
    s_waitcnt lgkmcnt(0)
    v_readfirstlane_b32 s8, v39
    s_cmp_ge_i32 s8, 386
    s_cbranch_scc1 Lc_150
    s_cmp_ge_i32 s8, 372
    s_cbranch_scc1 Lc_149
    s_waitcnt vmcnt(2)
Lc_149:
    s_waitcnt vmcnt(3)
Lc_150:
    s_waitcnt vmcnt(4)
    global_load_dwordx4 v[144:147], v2, s[6:7] offset:2048 nt
    s_mov_b64 exec, 1
    ds_add_rtn_u32 v39, v37, v38 offset:48
    s_mov_b64 exec, -1
    v_and_b32_dpp v16, v29, v8 row_newbcast:4 row_mask:0xf bank_mask:0xf
    v_and_b32_dpp v17, v29, v9 row_newbcast:4 row_mask:0xf bank_mask:0xf
    v_and_b32_dpp v18, v29, v10 row_newbcast:4 row_mask:0xf bank_mask:0xf
    v_and_b32_dpp v19, v29, v11 row_newbcast:4 row_mask:0xf bank_mask:0xf
    s_nop 1
    v_mfma_f32_16x16x32_bf16 v[20:23], v[124:127], v[16:19], v[20:23]
    s_waitcnt lgkmcnt(0)
    v_readfirstlane_b32 s8, v39
    s_cmp_ge_i32 s8, 394
    s_cbranch_scc1 Lc_153
    s_cmp_ge_i32 s8, 380
    s_cbranch_scc1 Lc_152
    s_waitcnt vmcnt(2)
Lc_152:
    s_waitcnt vmcnt(3)
Lc_153:
    s_waitcnt vmcnt(4)
    global_load_dwordx4 v[148:151], v2, s[6:7] offset:3072 nt
    s_add_u32 s6, s6, 32768
    s_addc_u32 s7, s7, 0
    s_mov_b64 exec, 1
    ds_add_rtn_u32 v39, v37, v38 offset:48
    s_mov_b64 exec, -1
    v_and_b32_dpp v12, v29, v8 row_newbcast:8 row_mask:0xf bank_mask:0xf
    v_and_b32_dpp v13, v29, v9 row_newbcast:8 row_mask:0xf bank_mask:0xf
    v_and_b32_dpp v14, v29, v10 row_newbcast:8 row_mask:0xf bank_mask:0xf
    v_and_b32_dpp v15, v29, v11 row_newbcast:8 row_mask:0xf bank_mask:0xf
    s_nop 1
    v_mfma_f32_16x16x32_bf16 v[20:23], v[128:131], v[12:15], v[20:23]
    s_waitcnt lgkmcnt(0)
    v_readfirstlane_b32 s8, v39
    s_cmp_ge_i32 s8, 402
    s_cbranch_scc1 Lc_156
    s_cmp_ge_i32 s8, 388
    s_cbranch_scc1 Lc_155
    s_waitcnt vmcnt(2)
Lc_155:
    s_waitcnt vmcnt(3)
Lc_156:
    s_waitcnt vmcnt(4)
    global_load_dwordx4 v[152:155], v2, s[6:7] offset:0 nt
    s_mov_b64 exec, 1
    ds_add_rtn_u32 v39, v37, v38 offset:48
    s_mov_b64 exec, -1
    v_and_b32_dpp v16, v29, v8 row_newbcast:12 row_mask:0xf bank_mask:0xf
    v_and_b32_dpp v17, v29, v9 row_newbcast:12 row_mask:0xf bank_mask:0xf
    v_and_b32_dpp v18, v29, v10 row_newbcast:12 row_mask:0xf bank_mask:0xf
    v_and_b32_dpp v19, v29, v11 row_newbcast:12 row_mask:0xf bank_mask:0xf
    s_nop 1
    v_mfma_f32_16x16x32_bf16 v[20:23], v[132:135], v[16:19], v[20:23]
    s_waitcnt lgkmcnt(0)
    v_readfirstlane_b32 s8, v39
    s_cmp_ge_i32 s8, 410
    s_cbranch_scc1 Lc_159
    s_cmp_ge_i32 s8, 396
    s_cbranch_scc1 Lc_158
    s_waitcnt vmcnt(2)
Lc_158:
    s_waitcnt vmcnt(3)
Lc_159:
    s_waitcnt vmcnt(4)
    global_load_dwordx4 v[156:159], v2, s[6:7] offset:1024 nt
    s_mov_b64 exec, 1
    ds_add_rtn_u32 v39, v37, v38 offset:48
    s_mov_b64 exec, -1
    v_and_b32_dpp v12, v30, v8 row_newbcast:0 row_mask:0xf bank_mask:0xf
    v_and_b32_dpp v13, v30, v9 row_newbcast:0 row_mask:0xf bank_mask:0xf
    v_and_b32_dpp v14, v30, v10 row_newbcast:0 row_mask:0xf bank_mask:0xf
    v_and_b32_dpp v15, v30, v11 row_newbcast:0 row_mask:0xf bank_mask:0xf
    s_nop 1
    v_mfma_f32_16x16x32_bf16 v[20:23], v[136:139], v[12:15], v[20:23]
    s_cmp_eq_u32 s52, 1
    s_cbranch_scc1 L_don_end
    s_waitcnt lgkmcnt(0)
    v_readfirstlane_b32 s8, v39
    s_cmp_ge_i32 s8, 418
    s_cbranch_scc1 Lc_162
    s_cmp_ge_i32 s8, 404
    s_cbranch_scc1 Lc_161
    s_waitcnt vmcnt(2)
Lc_161:
    s_waitcnt vmcnt(3)
Lc_162:
    s_waitcnt vmcnt(4)
    global_load_dwordx4 v[160:163], v2, s[6:7] offset:2048 nt
    s_mov_b64 exec, 1
    ds_add_rtn_u32 v39, v37, v38 offset:48
    s_mov_b64 exec, -1
    v_and_b32_dpp v16, v30, v8 row_newbcast:4 row_mask:0xf bank_mask:0xf
    v_and_b32_dpp v17, v30, v9 row_newbcast:4 row_mask:0xf bank_mask:0xf
    v_and_b32_dpp v18, v30, v10 row_newbcast:4 row_mask:0xf bank_mask:0xf
    v_and_b32_dpp v19, v30, v11 row_newbcast:4 row_mask:0xf bank_mask:0xf
    s_nop 1
    v_mfma_f32_16x16x32_bf16 v[20:23], v[140:143], v[16:19], v[20:23]
    s_waitcnt lgkmcnt(0)
    v_readfirstlane_b32 s8, v39
    s_cmp_ge_i32 s8, 426
    s_cbranch_scc1 Lc_165
    s_cmp_ge_i32 s8, 412
    s_cbranch_scc1 Lc_164
    s_waitcnt vmcnt(2)
Lc_164:
    s_waitcnt vmcnt(3)
Lc_165:
    s_waitcnt vmcnt(4)
    global_load_dwordx4 v[164:167], v2, s[6:7] offset:3072 nt
    s_mov_b64 exec, 1
    ds_add_rtn_u32 v39, v37, v38 offset:48
    s_mov_b64 exec, -1
    v_and_b32_dpp v12, v30, v8 row_newbcast:8 row_mask:0xf bank_mask:0xf
    v_and_b32_dpp v13, v30, v9 row_newbcast:8 row_mask:0xf bank_mask:0xf
    v_and_b32_dpp v14, v30, v10 row_newbcast:8 row_mask:0xf bank_mask:0xf
    v_and_b32_dpp v15, v30, v11 row_newbcast:8 row_mask:0xf bank_mask:0xf
    s_nop 1
    v_mfma_f32_16x16x32_bf16 v[20:23], v[144:147], v[12:15], v[20:23]
    s_cmp_eq_u32 s52, 2
    s_cbranch_scc1 L_recv_end
    s_waitcnt vmcnt(4)
    v_and_b32_dpp v16, v30, v8 row_newbcast:12 row_mask:0xf bank_mask:0xf
    v_and_b32_dpp v17, v30, v9 row_newbcast:12 row_mask:0xf bank_mask:0xf
    v_and_b32_dpp v18, v30, v10 row_newbcast:12 row_mask:0xf bank_mask:0xf
    v_and_b32_dpp v19, v30, v11 row_newbcast:12 row_mask:0xf bank_mask:0xf
    s_nop 1
    v_mfma_f32_16x16x32_bf16 v[20:23], v[148:151], v[16:19], v[20:23]
    s_waitcnt vmcnt(3)
    v_and_b32_dpp v12, v31, v8 row_newbcast:0 row_mask:0xf bank_mask:0xf
    v_and_b32_dpp v13, v31, v9 row_newbcast:0 row_mask:0xf bank_mask:0xf
    v_and_b32_dpp v14, v31, v10 row_newbcast:0 row_mask:0xf bank_mask:0xf
    v_and_b32_dpp v15, v31, v11 row_newbcast:0 row_mask:0xf bank_mask:0xf
    s_nop 1
    v_mfma_f32_16x16x32_bf16 v[20:23], v[152:155], v[12:15], v[20:23]
    s_waitcnt vmcnt(2)
    v_and_b32_dpp v16, v31, v8 row_newbcast:4 row_mask:0xf bank_mask:0xf
    v_and_b32_dpp v17, v31, v9 row_newbcast:4 row_mask:0xf bank_mask:0xf
    v_and_b32_dpp v18, v31, v10 row_newbcast:4 row_mask:0xf bank_mask:0xf
    v_and_b32_dpp v19, v31, v11 row_newbcast:4 row_mask:0xf bank_mask:0xf
    s_nop 1
    v_mfma_f32_16x16x32_bf16 v[20:23], v[156:159], v[16:19], v[20:23]
    s_waitcnt vmcnt(1)
    v_and_b32_dpp v12, v31, v8 row_newbcast:8 row_mask:0xf bank_mask:0xf
    v_and_b32_dpp v13, v31, v9 row_newbcast:8 row_mask:0xf bank_mask:0xf
    v_and_b32_dpp v14, v31, v10 row_newbcast:8 row_mask:0xf bank_mask:0xf
    v_and_b32_dpp v15, v31, v11 row_newbcast:8 row_mask:0xf bank_mask:0xf
    s_nop 1
    v_mfma_f32_16x16x32_bf16 v[20:23], v[160:163], v[12:15], v[20:23]
    s_waitcnt vmcnt(0)
    v_and_b32_dpp v16, v31, v8 row_newbcast:12 row_mask:0xf bank_mask:0xf
    v_and_b32_dpp v17, v31, v9 row_newbcast:12 row_mask:0xf bank_mask:0xf
    v_and_b32_dpp v18, v31, v10 row_newbcast:12 row_mask:0xf bank_mask:0xf
    v_and_b32_dpp v19, v31, v11 row_newbcast:12 row_mask:0xf bank_mask:0xf
    s_nop 1
    v_mfma_f32_16x16x32_bf16 v[20:23], v[164:167], v[16:19], v[20:23]
L_pv_end:
    v_lshrrev_b32 v3, 4, v0
    v_lshlrev_b32 v3, 7, v3
    v_and_b32 v4, 7, v0
    v_lshl_add_u32 v3, v4, 2, v3
    s_lshl_b32 s8, s3, 9
    v_add_u32 v3, s8, v3
    s_nop 1
    ds_write_b32 v3, v20 offset:4096
    ds_write_b32 v3, v21 offset:4128
    ds_write_b32 v3, v22 offset:4160
    ds_write_b32 v3, v23 offset:4192
    s_waitcnt lgkmcnt(0)
    s_barrier
    s_mov_b64 s[4:5], s[26:27]
    s_cmp_eq_u32 s43, 1
    s_cbranch_scc1 L_st_go
    s_cmp_ge_u32 s3, 4
    s_cbranch_scc1 L_stream_end
L_st_go:
    v_mov_b32 v12, 0
    s_mov_b32 s19, 18
    s_mov_b32 s18, 0
Llds_168:
    ds_read_b32 v3, v12 offset:16
    s_add_u32 s18, s18, 1
    s_cmp_gt_u32 s18, 400000
    s_cbranch_scc1 L_fail
    s_waitcnt lgkmcnt(0)
    v_readfirstlane_b32 s8, v3
    s_cmp_lt_u32 s8, 1
    s_cbranch_scc1 Llds_168
    s_and_b32 s40, s8, 3
    s_lshr_b32 s20, s8, 8
    v_lshrrev_b32 v3, 4, v0
    v_lshlrev_b32 v9, 10, v3
    v_bfe_u32 v3, v0, 2, 2
    v_lshl_add_u32 v9, v3, 7, v9
    v_bfe_u32 v3, v0, 3, 2
    v_lshl_add_u32 v9, v3, 5, v9
    v_and_b32 v3, 3, v0
    v_lshl_add_u32 v9, v3, 3, v9
    s_and_b32 s9, s3, 3
    s_lshl_b32 s9, s9, 5
    v_xor_b32 v9, s9, v9
    v_lshrrev_b32 v3, 4, v0
    v_lshlrev_b32 v11, 4, v3
    v_add_u32 v11, s25, v11
    v_and_b32 v13, 1, v0
    s_mov_b32 s14, 0x00030003
    s_mov_b32 s15, 0x00030003
    v_bfe_u32 v112, v0, 1, 1
    v_mul_u32_u24 v112, 2560, v112
    v_lshrrev_b32 v3, 3, v0
    v_mul_u32_u24 v14, 3456, v3
    v_bfe_u32 v3, v0, 4, 1
    v_lshlrev_b32 v3, 1, v3
    v_and_b32 v4, 7, v0
    v_xor_b32 v3, v3, v4
    v_lshl_add_u32 v14, v3, 4, v14
    v_lshrrev_b32 v3, 4, v0
    v_mul_u32_u24 v15, 1280, v3
    v_lshlrev_b32 v3, 1, v3
    v_and_b32 v4, 15, v0
    v_xor_b32 v3, v3, v4
    v_lshl_add_u32 v15, v3, 4, v15
    s_cmp_lt_u32 s24, 12
    s_cbranch_scc1 L_st_ffn
    s_cmp_ge_u32 s3, 4
    s_cbranch_scc1 L_st_wo_idle
    v_add_u32 v10, 90112, v9
    ds_read_b64_tr_b16 v[16:17], v10 offset:0
    ds_read_b64_tr_b16 v[18:19], v10 offset:512
    ds_read_b64_tr_b16 v[20:21], v10 offset:4096
    ds_read_b64_tr_b16 v[22:23], v10 offset:4608
    ds_read_b64_tr_b16 v[24:25], v10 offset:8192
    ds_read_b64_tr_b16 v[26:27], v10 offset:8704
    ds_read_b64_tr_b16 v[28:29], v10 offset:12288
    ds_read_b64_tr_b16 v[30:31], v10 offset:12800
    ds_read_b64_tr_b16 v[32:33], v10 offset:16384
    ds_read_b64_tr_b16 v[34:35], v10 offset:16896
    ds_read_b64_tr_b16 v[36:37], v10 offset:20480
    ds_read_b64_tr_b16 v[38:39], v10 offset:20992
    ds_read_b64_tr_b16 v[40:41], v10 offset:24576
    ds_read_b64_tr_b16 v[42:43], v10 offset:25088
    ds_read_b64_tr_b16 v[44:45], v10 offset:28672
    ds_read_b64_tr_b16 v[46:47], v10 offset:29184
    v_and_b32 v3, 1, v0
    v_mul_u32_u24 v10, 512, v3
    v_lshrrev_b32 v3, 4, v0
    v_lshl_add_u32 v10, v3, 4, v10
    s_lshl_b32 s8, s3, 7
    s_add_u32 s8, s8, 3072
    v_lshl_add_u32 v4, v13, 6, v11
    v_add_u32 v4, s8, v4
    v_add_u32 v4, v112, v4
    s_waitcnt lgkmcnt(0)
    s_barrier
    ds_read_b128 v[72:75], v10 offset:1024
    ds_read_b128 v[76:79], v10 offset:1088
    ds_read_b128 v[80:83], v10 offset:1152
    ds_read_b128 v[84:87], v10 offset:1216
    ds_read_b128 v[88:91], v10 offset:1280
    ds_read_b128 v[92:95], v10 offset:1344
    ds_read_b128 v[96:99], v10 offset:1408
    ds_read_b128 v[100:103], v10 offset:1472
    s_waitcnt lgkmcnt(7)
    v_mfma_f32_16x16x32_bf16 v[104:107], v[16:19], v[72:75], 0
    s_waitcnt lgkmcnt(6)
    v_mfma_f32_16x16x32_bf16 v[108:111], v[20:23], v[76:79], 0
    s_waitcnt lgkmcnt(5)
    v_mfma_f32_16x16x32_bf16 v[104:107], v[24:27], v[80:83], v[104:107]
    s_waitcnt lgkmcnt(4)
    v_mfma_f32_16x16x32_bf16 v[108:111], v[28:31], v[84:87], v[108:111]
    s_waitcnt lgkmcnt(3)
    v_mfma_f32_16x16x32_bf16 v[104:107], v[32:35], v[88:91], v[104:107]
    s_waitcnt lgkmcnt(2)
    v_mfma_f32_16x16x32_bf16 v[108:111], v[36:39], v[92:95], v[108:111]
    s_waitcnt lgkmcnt(1)
    v_mfma_f32_16x16x32_bf16 v[104:107], v[40:43], v[96:99], v[104:107]
    s_waitcnt lgkmcnt(0)
    v_mfma_f32_16x16x32_bf16 v[108:111], v[44:47], v[100:103], v[108:111]
    s_nop 7
    v_pk_add_f32 v[104:105], v[104:105], v[108:109]
    v_pk_add_f32 v[106:107], v[106:107], v[110:111]
    v_mov_b32_sdwa v104, s20 dst_sel:BYTE_0 dst_unused:UNUSED_PRESERVE src0_sel:BYTE_0
    v_mov_b32_sdwa v105, s20 dst_sel:BYTE_0 dst_unused:UNUSED_PRESERVE src0_sel:BYTE_0
    v_mov_b32_sdwa v106, s20 dst_sel:BYTE_0 dst_unused:UNUSED_PRESERVE src0_sel:BYTE_0
    v_mov_b32_sdwa v107, s20 dst_sel:BYTE_0 dst_unused:UNUSED_PRESERVE src0_sel:BYTE_0
    s_mov_b32 exec_lo, 0x000f000f
    s_mov_b32 exec_hi, 0x000f000f
    global_store_dwordx4 v4, v[104:107], s[4:5] sc1
    s_mov_b64 exec, -1
    v_mov_b32 v3, 1
    s_mov_b64 s[16:17], exec
    s_mov_b64 exec, 1
    ds_add_u32 v12, v3 offset:24
    s_mov_b64 exec, s[16:17]
    s_branch L_st_wo_done
L_st_wo_idle:
    s_barrier
L_st_wo_done:
    s_cmp_eq_u32 s43, 0
    s_cbranch_scc1 L_stream_end
L_st_ffn:
    v_lshrrev_b32 v3, 4, v0
    v_lshlrev_b32 v8, 11, v3
    v_bfe_u32 v3, v0, 2, 2
    v_lshl_add_u32 v8, v3, 8, v8
    v_lshl_add_u32 v8, v3, 5, v8
    v_bfe_u32 v3, v0, 4, 1
    v_lshl_add_u32 v8, v3, 7, v8
    v_and_b32 v3, 3, v0
    v_lshl_add_u32 v8, v3, 3, v8
    s_lshl_b32 s8, s3, 5
    v_xor_b32 v8, s8, v8
    s_lshr_b32 s10, s3, 2
    s_lshl_b32 s10, s10, 14
    v_add_u32 v10, s10, v9
    v_mov_b32 v9, v10
    v_lshl_add_u32 v11, v13, 6, v11
    s_lshl_b32 s9, s3, 7
    v_add_u32 v11, s9, v11
    s_cmp_ge_u32 s24, 12
    s_cselect_b32 s8, s3, 0
    s_cmp_ge_u32 s8, 4
    s_cbranch_scc1 L_st_nogo
    s_mov_b32 s19, 20
    s_mov_b32 s18, 0
Llds_169:
    ds_read_b32 v3, v12 offset:24
    s_add_u32 s18, s18, 1
    s_cmp_gt_u32 s18, 400000
    s_cbranch_scc1 L_fail
    s_waitcnt lgkmcnt(0)
    v_readfirstlane_b32 s8, v3
    s_cmp_lt_u32 s8, 4
    s_cbranch_scc1 Llds_169
L_st_nogo:
    s_mul_i32 s10, s3, 27648
    s_add_u32 s28, s28, s10
    s_addc_u32 s29, s29, 0
    s_lshl_b32 s11, s3, 10
    s_add_u32 s11, s11, 8192
    s_mov_b32 s12, s3
Ldma_170:
    s_mov_b32 m0, s11
    s_bitcmp1_b32 s12, 0
    s_cselect_b32 s13, 64, 0
    v_xor_b32 v7, s13, v14
    s_add_u32 s11, s11, 8192
    global_load_lds_dwordx4 v7, s[28:29] nt
    s_add_u32 s28, s28, 221184
    s_addc_u32 s29, s29, 0
    s_add_u32 s12, s12, 8
    s_cmp_lt_u32 s12, 16
    s_cbranch_scc1 Ldma_170
    s_mul_i32 s10, s3, 27648
    s_add_u32 s30, s30, s10
    s_addc_u32 s31, s31, 0
    s_lshl_b32 s11, s3, 10
    s_add_u32 s11, s11, 24576
    s_mov_b32 s12, s3
Ldma_171:
    s_mov_b32 m0, s11
    s_bitcmp1_b32 s12, 0
    s_cselect_b32 s13, 64, 0
    v_xor_b32 v7, s13, v14
    s_add_u32 s11, s11, 8192
    global_load_lds_dwordx4 v7, s[30:31] nt
    s_add_u32 s30, s30, 221184
    s_addc_u32 s31, s31, 0
    s_add_u32 s12, s12, 8
    s_cmp_lt_u32 s12, 16
    s_cbranch_scc1 Ldma_171
    s_mul_i32 s10, s3, 5120
    s_add_u32 s32, s32, s10
    s_addc_u32 s33, s33, 0
    s_lshl_b32 s11, s3, 10
    s_add_u32 s11, s11, 40960
    s_mov_b32 s12, s3
Ldma_172:
    s_mov_b32 m0, s11
    s_bitcmp1_b32 s12, 1
    s_cselect_b32 s13, 128, 0
    v_xor_b32 v7, s13, v15
    s_add_u32 s11, s11, 8192
    global_load_lds_dwordx4 v7, s[32:33] nt
    s_add_u32 s32, s32, 40960
    s_addc_u32 s33, s33, 0
    s_add_u32 s12, s12, 8
    s_cmp_lt_u32 s12, 16
    s_cbranch_scc1 Ldma_172
    s_waitcnt vmcnt(2)
    v_mov_b32 v3, 1
    s_mov_b64 s[16:17], exec
    s_mov_b64 exec, 1
    ds_add_u32 v12, v3 offset:28
    s_mov_b64 exec, s[16:17]
    s_mov_b32 s19, 19
    s_mov_b32 s18, 0
Llds_173:
    ds_read_b32 v3, v12 offset:28
    s_add_u32 s18, s18, 1
    s_cmp_gt_u32 s18, 400000
    s_cbranch_scc1 L_fail
    s_waitcnt lgkmcnt(0)
    v_readfirstlane_b32 s8, v3
    s_cmp_lt_u32 s8, 8
    s_cbranch_scc1 Llds_173
    ds_read_b64_tr_b16 v[48:49], v9 offset:8192
    ds_read_b64_tr_b16 v[50:51], v9 offset:8704
    ds_read_b64_tr_b16 v[52:53], v9 offset:12288
    ds_read_b64_tr_b16 v[54:55], v9 offset:12800
    ds_read_b64_tr_b16 v[56:57], v9 offset:16384
    ds_read_b64_tr_b16 v[58:59], v9 offset:16896
    ds_read_b64_tr_b16 v[60:61], v9 offset:20480
    ds_read_b64_tr_b16 v[62:63], v9 offset:20992
    v_and_b32 v3, 1, v0
    v_mul_u32_u24 v10, 256, v3
    v_lshrrev_b32 v3, 4, v0
    v_lshl_add_u32 v10, v3, 4, v10
    v_add_u32 v3, 1024, v11
    s_waitcnt lgkmcnt(0)
    s_barrier
    ds_read_b128 v[72:75], v10 offset:2048
    ds_read_b128 v[76:79], v10 offset:2112
    ds_read_b128 v[80:83], v10 offset:2176
    ds_read_b128 v[84:87], v10 offset:2240
    s_waitcnt lgkmcnt(3)
    v_mfma_f32_16x16x32_bf16 v[104:107], v[48:51], v[72:75], 0
    s_waitcnt lgkmcnt(2)
    v_mfma_f32_16x16x32_bf16 v[104:107], v[52:55], v[76:79], v[104:107]
    s_waitcnt lgkmcnt(1)
    v_mfma_f32_16x16x32_bf16 v[104:107], v[56:59], v[80:83], v[104:107]
    s_waitcnt lgkmcnt(0)
    v_mfma_f32_16x16x32_bf16 v[104:107], v[60:63], v[84:87], v[104:107]
    s_nop 7
    v_mov_b32_sdwa v104, s20 dst_sel:BYTE_0 dst_unused:UNUSED_PRESERVE src0_sel:BYTE_0
    v_mov_b32_sdwa v105, s20 dst_sel:BYTE_0 dst_unused:UNUSED_PRESERVE src0_sel:BYTE_0
    v_mov_b32_sdwa v106, s20 dst_sel:BYTE_0 dst_unused:UNUSED_PRESERVE src0_sel:BYTE_0
    v_mov_b32_sdwa v107, s20 dst_sel:BYTE_0 dst_unused:UNUSED_PRESERVE src0_sel:BYTE_0
    s_mov_b64 exec, s[14:15]
    s_cmp_eq_u32 s40, 1
    s_cbranch_scc0 Lg_174
    global_store_dwordx4 v3, v[104:107], s[4:5]
Lj_175:
    s_mov_b64 exec, -1
    s_waitcnt vmcnt(1)
    v_mov_b32 v4, 1
    s_mov_b64 s[16:17], exec
    s_mov_b64 exec, 1
    ds_add_u32 v12, v4 offset:32
    s_mov_b64 exec, s[16:17]
    s_mov_b32 s19, 21
    s_mov_b32 s18, 0
Llds_176:
    ds_read_b32 v4, v12 offset:32
    s_add_u32 s18, s18, 1
    s_cmp_gt_u32 s18, 400000
    s_cbranch_scc1 L_fail
    s_waitcnt lgkmcnt(0)
    v_readfirstlane_b32 s8, v4
    s_cmp_lt_u32 s8, 8
    s_cbranch_scc1 Llds_176
    ds_read_b64_tr_b16 v[64:65], v8 offset:40960
    ds_read_b64_tr_b16 v[66:67], v8 offset:41984
    ds_read_b64_tr_b16 v[68:69], v8 offset:49152
    ds_read_b64_tr_b16 v[70:71], v8 offset:50176
    v_and_b32 v3, 1, v0
    v_mul_u32_u24 v10, 128, v3
    v_lshrrev_b32 v3, 4, v0
    v_lshl_add_u32 v10, v3, 4, v10
    v_add_u32 v3, 2048, v11
    v_add_u32 v3, v112, v3
    s_waitcnt lgkmcnt(0)
    s_barrier
    ds_read_b128 v[72:75], v10 offset:2560
    ds_read_b128 v[76:79], v10 offset:2624
    s_waitcnt lgkmcnt(1)
    v_mfma_f32_16x16x32_bf16 v[104:107], v[64:67], v[72:75], 0
    s_waitcnt lgkmcnt(0)
    v_mfma_f32_16x16x32_bf16 v[104:107], v[68:71], v[76:79], v[104:107]
    s_nop 7
    v_mov_b32_sdwa v104, s20 dst_sel:BYTE_0 dst_unused:UNUSED_PRESERVE src0_sel:BYTE_0
    v_mov_b32_sdwa v105, s20 dst_sel:BYTE_0 dst_unused:UNUSED_PRESERVE src0_sel:BYTE_0
    v_mov_b32_sdwa v106, s20 dst_sel:BYTE_0 dst_unused:UNUSED_PRESERVE src0_sel:BYTE_0
    v_mov_b32_sdwa v107, s20 dst_sel:BYTE_0 dst_unused:UNUSED_PRESERVE src0_sel:BYTE_0
    s_mov_b32 exec_lo, 0x000f000f
    s_mov_b32 exec_hi, 0x000f000f
    global_store_dwordx4 v3, v[104:107], s[4:5] sc1
    s_mov_b64 exec, -1
L_stream_end:
    s_endpgm
L_helper:
    s_setprio 3
    s_sub_u32 s22, s3, 8
    s_load_dwordx2 s[4:5], s[0:1], 104
    s_load_dwordx2 s[6:7], s[0:1], 80
    s_load_dwordx4 s[28:31], s[0:1], 24
    s_load_dwordx2 s[48:49], s[0:1], 72
    s_load_dwordx2 s[32:33], s[0:1], 0
    v_mov_b32 v1, 0
    s_getreg_b32 s41, hwreg(HW_REG_XCC_ID, 0, 4)
    s_mul_i32 s42, s23, 200704
    s_add_u32 s42, s42, 40960
    s_mul_i32 s25, s24, 6272
    s_add_u32 s25, s25, s42
    s_lshl_b32 s37, s24, 2
    s_and_b32 s8, s23, 3
    s_add_u32 s37, s37, s8
    s_cmp_ge_u32 s23, 4
    s_cselect_b32 s8, 20, 0
    s_add_u32 s37, s37, s8
    s_lshl_b32 s8, s24, 3
    s_add_u32 s8, s8, s23
    s_cmp_ge_u32 s24, 5
    s_cselect_b32 s37, s8, s37
    s_cmp_lt_u32 s37, 60
    s_cselect_b32 s38, 2, 0
    s_cmp_lt_u32 s37, 20
    s_cselect_b32 s38, 1, s38
    s_cmp_ge_u32 s24, 8
    s_cselect_b32 s38, 3, s38
    s_cmp_ge_u32 s24, 28
    s_cselect_b32 s38, 0, s38
    s_sub_u32 s8, s22, 1
    s_cmp_eq_u32 s38, 2
    s_cselect_b32 s27, s8, s22
    s_sub_u32 s8, s24, 8
    s_and_b32 s9, s8, 3
    s_lshr_b32 s26, s8, 2
    s_lshl_b32 s8, s23, 2
    s_add_u32 s9, s9, s8
    s_mul_i32 s8, s26, 1048576
    s_lshl_b32 s9, s9, 8
    s_add_u32 s14, s8, s9
    s_cmp_lg_u32 s22, 0
    s_cbranch_scc1 L_h_noinit
    v_lshlrev_b32 v2, 2, v0
    v_subrev_u32 v3, 16, v0
    v_cmp_gt_u32 vcc, 18, v3
    s_nop 1
    v_cndmask_b32 v3, 0, -1, vcc
    ds_write_b32 v2, v3
    ds_write_b32 v2, v1 offset:512
L_h_noinit:
    s_lshl_b32 s8, s27, 6
    v_add_u32 v10, s8, v0
    v_min_u32 v10, 159, v10
    v_lshlrev_b32 v10, 4, v10
    s_waitcnt lgkmcnt(0)
    global_load_dwordx2 v[40:41], v1, s[4:5] sc1
    s_cmp_eq_u32 s38, 1
    s_cbranch_scc1 L_h_c
    s_cmp_lg_u32 s38, 2
    s_cbranch_scc1 L_h_noc
    s_cmp_eq_u32 s22, 0
    s_cbranch_scc1 L_h_noc
L_h_c:
    global_load_dwordx4 v[44:47], v10, s[48:49]
L_h_noc:
    s_cmp_lg_u32 s22, 3
    s_cbranch_scc1 L_h_noclr
    v_lshlrev_b32 v2, 6, v0
    v_add_u32 v2, s25, v2
    v_add_u32 v3, 4096, v2
    s_mov_b32 exec_hi, 0xffff0000
    global_load_dword v12, v2, s[4:5] sc1
    s_mov_b32 exec_lo, 0xff
    s_mov_b32 exec_hi, 1
    global_load_dword v13, v3, s[4:5] sc1
    s_mov_b64 exec, -1
    s_cmp_lg_u32 s38, 3
    s_cbranch_scc1 L_h_noclr
    v_lshrrev_b32 v2, 5, v0
    v_mul_u32_u24 v2, 1280, v2
    v_and_b32 v3, 31, v0
    v_lshl_add_u32 v2, v3, 3, v2
    s_mov_b32 s9, s26
    s_lshl_b32 s8, s9, 8
    v_add_u32 v3, s8, v2
    global_load_dwordx2 v[24:25], v3, s[32:33]
    s_add_u32 s9, s9, 1
    s_cmp_eq_u32 s9, 5
    s_cselect_b32 s9, 0, s9
    s_lshl_b32 s8, s9, 8
    v_add_u32 v3, s8, v2
    global_load_dwordx2 v[26:27], v3, s[32:33]
    s_add_u32 s9, s9, 1
    s_cmp_eq_u32 s9, 5
    s_cselect_b32 s9, 0, s9
    s_lshl_b32 s8, s9, 8
    v_add_u32 v3, s8, v2
    global_load_dwordx2 v[28:29], v3, s[32:33]
    s_add_u32 s9, s9, 1
    s_cmp_eq_u32 s9, 5
    s_cselect_b32 s9, 0, s9
    s_lshl_b32 s8, s9, 8
    v_add_u32 v3, s8, v2
    global_load_dwordx2 v[30:31], v3, s[32:33]
    s_add_u32 s9, s9, 1
    s_cmp_eq_u32 s9, 5
    s_cselect_b32 s9, 0, s9
    s_lshl_b32 s8, s9, 8
    v_add_u32 v3, s8, v2
    global_load_dwordx2 v[32:33], v3, s[32:33]
L_h_noclr:
    s_lshl_b32 s8, s37, 7
    s_add_u32 s6, s6, s8
    s_addc_u32 s7, s7, 0
    s_cmp_lg_u32 s38, 1
    s_cbranch_scc1 L_h_nourg
    v_lshrrev_b32 v2, 3, v0
    v_mul_u32_u24 v6, 7680, v2
    v_bfe_u32 v2, v0, 4, 1
    v_lshlrev_b32 v2, 1, v2
    v_and_b32 v3, 7, v0
    v_xor_b32 v2, v2, v3
    v_lshl_add_u32 v6, v2, 4, v6
    s_mul_i32 s10, s22, 61440
    s_add_u32 s6, s6, s10
    s_addc_u32 s7, s7, 0
    s_lshl_b32 s11, s22, 10
    s_add_u32 s11, s11, 8192
    s_mov_b32 s12, s22
Ldma_177:
    s_mov_b32 m0, s11
    s_bitcmp1_b32 s12, 0
    s_cselect_b32 s13, 64, 0
    v_xor_b32 v8, s13, v6
    s_add_u32 s11, s11, 4096
    global_load_lds_dwordx4 v8, s[6:7] nt
    s_add_u32 s6, s6, 245760
    s_addc_u32 s7, s7, 0
    s_add_u32 s12, s12, 4
    s_cmp_lt_u32 s12, 80
    s_cbranch_scc1 Ldma_177
L_h_nourg:
    s_barrier
    s_cmp_eq_u32 s38, 3
    s_cbranch_scc1 L_cls_q
    s_cmp_eq_u32 s38, 2
    s_cbranch_scc1 L_cls_d
    s_cmp_eq_u32 s38, 0
    s_cbranch_scc1 L_cls_n
    s_waitcnt vmcnt(20)
    v_readfirstlane_b32 s20, v40
    v_readfirstlane_b32 s21, v41
    s_add_u32 s20, s20, 1
    s_and_b32 s98, s20, 0xff
    s_sub_u32 s96, 0, s98
    s_subb_u32 s97, 0, s98
    s_cmp_lg_u32 s22, 3
    s_cbranch_scc1 Lnf_178
    s_xor_b32 s9, s21, s41
    v_mov_b32 v4, s20
    v_mov_b32 v5, s9
    s_lshl_b32 s8, s23, 5
    s_add_u32 s8, s8, s24
    s_lshl_b32 s8, s8, 3
    s_add_u32 s8, s8, 4096
    v_mov_b32 v2, s8
    s_mov_b64 exec, 1
    global_store_dwordx2 v2, v[4:5], s[4:5] sc1
    s_mov_b64 exec, -1
Lnf_178:
    v_lshlrev_b32 v12, 16, v44
    v_and_b32 v13, 0xffff0000, v44
    v_lshlrev_b32 v14, 16, v45
    v_and_b32 v15, 0xffff0000, v45
    v_lshlrev_b32 v16, 16, v46
    v_and_b32 v17, 0xffff0000, v46
    v_lshlrev_b32 v18, 16, v47
    v_and_b32 v19, 0xffff0000, v47
    s_mov_b32 s8, 0xbfb8aa3b
    s_mov_b32 s9, 0xb2a57060
    s_mov_b32 s10, 0x3f317218
    v_mul_f32 v48, s8, v12
    v_mul_f32 v49, s8, v13
    v_mul_f32 v50, s8, v14
    v_mul_f32 v51, s8, v15
    v_mul_f32 v52, s8, v16
    v_mul_f32 v53, s8, v17
    v_mul_f32 v54, s8, v18
    v_mul_f32 v55, s8, v19
    v_fma_f32 v56, s8, v12, -v48
    v_fma_f32 v57, s8, v13, -v49
    v_fma_f32 v58, s8, v14, -v50
    v_fma_f32 v59, s8, v15, -v51
    v_fma_f32 v60, s8, v16, -v52
    v_fma_f32 v61, s8, v17, -v53
    v_fma_f32 v62, s8, v18, -v54
    v_fma_f32 v63, s8, v19, -v55
    v_fmac_f32 v56, s9, v12
    v_fmac_f32 v57, s9, v13
    v_fmac_f32 v58, s9, v14
    v_fmac_f32 v59, s9, v15
    v_fmac_f32 v60, s9, v16
    v_fmac_f32 v61, s9, v17
    v_fmac_f32 v62, s9, v18
    v_fmac_f32 v63, s9, v19
    v_min_f32 v48, 0x42fc0000, v48
    v_min_f32 v49, 0x42fc0000, v49
    v_min_f32 v50, 0x42fc0000, v50
    v_min_f32 v51, 0x42fc0000, v51
    v_min_f32 v52, 0x42fc0000, v52
    v_min_f32 v53, 0x42fc0000, v53
    v_min_f32 v54, 0x42fc0000, v54
    v_min_f32 v55, 0x42fc0000, v55
    v_exp_f32 v48, v48
    v_exp_f32 v49, v49
    v_exp_f32 v50, v50
    v_exp_f32 v51, v51
    v_exp_f32 v52, v52
    v_exp_f32 v53, v53
    v_exp_f32 v54, v54
    v_exp_f32 v55, v55
    v_mul_f32 v56, s10, v56
    v_mul_f32 v57, s10, v57
    v_mul_f32 v58, s10, v58
    v_mul_f32 v59, s10, v59
    v_mul_f32 v60, s10, v60
    v_mul_f32 v61, s10, v61
    v_mul_f32 v62, s10, v62
    v_mul_f32 v63, s10, v63
    v_fmac_f32 v48, v48, v56
    v_fmac_f32 v49, v49, v57
    v_fmac_f32 v50, v50, v58
    v_fmac_f32 v51, v51, v59
    v_fmac_f32 v52, v52, v60
    v_fmac_f32 v53, v53, v61
    v_fmac_f32 v54, v54, v62
    v_fmac_f32 v55, v55, v63
    v_add_f32 v48, 1.0, v48
    v_add_f32 v49, 1.0, v49
    v_add_f32 v50, 1.0, v50
    v_add_f32 v51, 1.0, v51
    v_add_f32 v52, 1.0, v52
    v_add_f32 v53, 1.0, v53
    v_add_f32 v54, 1.0, v54
    v_add_f32 v55, 1.0, v55
    v_rcp_f32 v56, v48
    v_rcp_f32 v57, v49
    v_rcp_f32 v58, v50
    v_rcp_f32 v59, v51
    v_rcp_f32 v60, v52
    v_rcp_f32 v61, v53
    v_rcp_f32 v62, v54
    v_rcp_f32 v63, v55
    v_mul_f32 v44, v12, v56
    v_fma_f32 v48, -v44, v48, v12
    v_fma_f32 v12, v48, v56, v44
    v_mul_f32 v45, v13, v57
    v_fma_f32 v49, -v45, v49, v13
    v_fma_f32 v13, v49, v57, v45
    v_mul_f32 v46, v14, v58
    v_fma_f32 v50, -v46, v50, v14
    v_fma_f32 v14, v50, v58, v46
    v_mul_f32 v47, v15, v59
    v_fma_f32 v51, -v47, v51, v15
    v_fma_f32 v15, v51, v59, v47
    v_mul_f32 v44, v16, v60
    v_fma_f32 v52, -v44, v52, v16
    v_fma_f32 v16, v52, v60, v44
    v_mul_f32 v45, v17, v61
    v_fma_f32 v53, -v45, v53, v17
    v_fma_f32 v17, v53, v61, v45
    v_mul_f32 v46, v18, v62
    v_fma_f32 v54, -v46, v54, v18
    v_fma_f32 v18, v54, v62, v46
    v_mul_f32 v47, v19, v63
    v_fma_f32 v55, -v47, v55, v19
    v_fma_f32 v19, v55, v63, v47
    v_cvt_pk_bf16_f32 v44, v12, v13
    v_cvt_pk_bf16_f32 v45, v14, v15
    v_cvt_pk_bf16_f32 v46, v16, v17
    v_cvt_pk_bf16_f32 v47, v18, v19
    ds_write_b128 v10, v[44:47] offset:1024
    s_waitcnt lgkmcnt(0)
    v_mov_b32 v2, 1
    s_mov_b64 s[16:17], exec
    s_mov_b64 exec, 1
    ds_add_u32 v1, v2 offset:20
    s_mov_b64 exec, s[16:17]
    v_lshrrev_b32 v2, 4, v0
    v_lshlrev_b32 v9, 10, v2
    v_bfe_u32 v2, v0, 2, 2
    v_lshl_add_u32 v9, v2, 7, v9
    v_bfe_u32 v2, v0, 3, 2
    v_lshl_add_u32 v9, v2, 5, v9
    v_and_b32 v2, 3, v0
    v_lshl_add_u32 v9, v2, 3, v9
    v_add_u32 v9, 8192, v9
    v_and_b32 v2, 1, v0
    v_mul_u32_u24 v11, 1280, v2
    v_lshrrev_b32 v2, 4, v0
    v_lshl_add_u32 v11, v2, 4, v11
    v_and_b32 v2, 1, v0
    v_lshlrev_b32 v12, 8, v2
    v_lshrrev_b32 v2, 4, v0
    v_lshl_add_u32 v12, v2, 4, v12
    s_lshl_b32 s8, s37, 9
    s_add_u32 s8, s8, 8192
    v_add_u32 v12, s8, v12
    s_mov_b32 s19, 33
    s_mov_b32 s18, 0
Llds_179:
    ds_read_b32 v2, v1 offset:20
    s_add_u32 s18, s18, 1
    s_cmp_gt_u32 s18, 400000
    s_cbranch_scc1 L_fail
    s_waitcnt lgkmcnt(0)
    v_readfirstlane_b32 s8, v2
    s_cmp_lt_u32 s8, 4
    s_cbranch_scc1 Llds_179
    ds_read_b128 v[80:83], v11 offset:1024
    ds_read_b128 v[84:87], v11 offset:1088
    ds_read_b128 v[88:91], v11 offset:1152
    ds_read_b128 v[92:95], v11 offset:1216
    ds_read_b128 v[96:99], v11 offset:1280
    ds_read_b128 v[100:103], v11 offset:1344
    ds_read_b128 v[104:107], v11 offset:1408
    ds_read_b128 v[108:111], v11 offset:1472
    ds_read_b128 v[112:115], v11 offset:1536
    ds_read_b128 v[116:119], v11 offset:1600
    ds_read_b128 v[120:123], v11 offset:1664
    ds_read_b128 v[124:127], v11 offset:1728
    ds_read_b128 v[128:131], v11 offset:1792
    ds_read_b128 v[132:135], v11 offset:1856
    ds_read_b128 v[136:139], v11 offset:1920
    ds_read_b128 v[140:143], v11 offset:1984
    ds_read_b128 v[144:147], v11 offset:2048
    ds_read_b128 v[148:151], v11 offset:2112
    ds_read_b128 v[152:155], v11 offset:2176
    ds_read_b128 v[156:159], v11 offset:2240
    s_waitcnt vmcnt(0)
    v_mov_b32 v2, 1
    s_mov_b64 s[16:17], exec
    s_mov_b64 exec, 1
    ds_add_u32 v1, v2 offset:0
    s_mov_b64 exec, s[16:17]
    s_mov_b32 s19, 32
    s_mov_b32 s18, 0
Llds_180:
    ds_read_b32 v2, v1 offset:0
    s_add_u32 s18, s18, 1
    s_cmp_gt_u32 s18, 400000
    s_cbranch_scc1 L_fail
    s_waitcnt lgkmcnt(0)
    v_readfirstlane_b32 s8, v2
    s_cmp_lt_u32 s8, 4
    s_cbranch_scc1 Llds_180
    s_mov_b32 s12, s27
Lmb_181:
    s_lshl_b32 s8, s12, 5
    v_xor_b32 v13, s8, v9
    v_add_u32 v10, 40960, v13
    ds_read_b64_tr_b16 v[40:41], v13 offset:0
    ds_read_b64_tr_b16 v[42:43], v13 offset:512
    ds_read_b64_tr_b16 v[44:45], v13 offset:4096
    ds_read_b64_tr_b16 v[46:47], v13 offset:4608
    ds_read_b64_tr_b16 v[48:49], v13 offset:8192
    ds_read_b64_tr_b16 v[50:51], v13 offset:8704
    ds_read_b64_tr_b16 v[52:53], v13 offset:12288
    ds_read_b64_tr_b16 v[54:55], v13 offset:12800
    ds_read_b64_tr_b16 v[56:57], v13 offset:16384
    ds_read_b64_tr_b16 v[58:59], v13 offset:16896
    ds_read_b64_tr_b16 v[60:61], v13 offset:20480
    ds_read_b64_tr_b16 v[62:63], v13 offset:20992
    ds_read_b64_tr_b16 v[64:65], v13 offset:24576
    ds_read_b64_tr_b16 v[66:67], v13 offset:25088
    ds_read_b64_tr_b16 v[68:69], v13 offset:28672
    ds_read_b64_tr_b16 v[70:71], v13 offset:29184
    ds_read_b64_tr_b16 v[72:73], v13 offset:32768
    ds_read_b64_tr_b16 v[74:75], v13 offset:33280
    ds_read_b64_tr_b16 v[76:77], v13 offset:36864
    ds_read_b64_tr_b16 v[78:79], v13 offset:37376
    s_waitcnt lgkmcnt(10)
    v_mfma_f32_16x16x32_bf16 v[32:35], v[40:43], v[80:83], 0
    v_mfma_f32_16x16x32_bf16 v[36:39], v[44:47], v[84:87], 0
    v_mfma_f32_16x16x32_bf16 v[32:35], v[48:51], v[88:91], v[32:35]
    v_mfma_f32_16x16x32_bf16 v[36:39], v[52:55], v[92:95], v[36:39]
    v_mfma_f32_16x16x32_bf16 v[32:35], v[56:59], v[96:99], v[32:35]
    ds_read_b64_tr_b16 v[40:41], v10 offset:0
    ds_read_b64_tr_b16 v[42:43], v10 offset:512
    ds_read_b64_tr_b16 v[44:45], v10 offset:4096
    ds_read_b64_tr_b16 v[46:47], v10 offset:4608
    ds_read_b64_tr_b16 v[48:49], v10 offset:8192
    ds_read_b64_tr_b16 v[50:51], v10 offset:8704
    ds_read_b64_tr_b16 v[52:53], v10 offset:12288
    ds_read_b64_tr_b16 v[54:55], v10 offset:12800
    ds_read_b64_tr_b16 v[56:57], v10 offset:16384
    ds_read_b64_tr_b16 v[58:59], v10 offset:16896
    s_waitcnt lgkmcnt(10)
    v_mfma_f32_16x16x32_bf16 v[36:39], v[60:63], v[100:103], v[36:39]
    v_mfma_f32_16x16x32_bf16 v[32:35], v[64:67], v[104:107], v[32:35]
    v_mfma_f32_16x16x32_bf16 v[36:39], v[68:71], v[108:111], v[36:39]
    v_mfma_f32_16x16x32_bf16 v[32:35], v[72:75], v[112:115], v[32:35]
    v_mfma_f32_16x16x32_bf16 v[36:39], v[76:79], v[116:119], v[36:39]
    ds_read_b64_tr_b16 v[60:61], v10 offset:20480
    ds_read_b64_tr_b16 v[62:63], v10 offset:20992
    ds_read_b64_tr_b16 v[64:65], v10 offset:24576
    ds_read_b64_tr_b16 v[66:67], v10 offset:25088
    ds_read_b64_tr_b16 v[68:69], v10 offset:28672
    ds_read_b64_tr_b16 v[70:71], v10 offset:29184
    ds_read_b64_tr_b16 v[72:73], v10 offset:32768
    ds_read_b64_tr_b16 v[74:75], v10 offset:33280
    ds_read_b64_tr_b16 v[76:77], v10 offset:36864
    ds_read_b64_tr_b16 v[78:79], v10 offset:37376
    s_waitcnt lgkmcnt(10)
    v_mfma_f32_16x16x32_bf16 v[32:35], v[40:43], v[120:123], v[32:35]
    v_mfma_f32_16x16x32_bf16 v[36:39], v[44:47], v[124:127], v[36:39]
    v_mfma_f32_16x16x32_bf16 v[32:35], v[48:51], v[128:131], v[32:35]
    v_mfma_f32_16x16x32_bf16 v[36:39], v[52:55], v[132:135], v[36:39]
    v_mfma_f32_16x16x32_bf16 v[32:35], v[56:59], v[136:139], v[32:35]
    s_waitcnt lgkmcnt(0)
    v_mfma_f32_16x16x32_bf16 v[36:39], v[60:63], v[140:143], v[36:39]
    v_mfma_f32_16x16x32_bf16 v[32:35], v[64:67], v[144:147], v[32:35]
    v_mfma_f32_16x16x32_bf16 v[36:39], v[68:71], v[148:151], v[36:39]
    v_mfma_f32_16x16x32_bf16 v[32:35], v[72:75], v[152:155], v[32:35]
    v_mfma_f32_16x16x32_bf16 v[36:39], v[76:79], v[156:159], v[36:39]
    s_nop 7
    v_pk_add_f32 v[32:33], v[32:33], v[36:37]
    v_pk_add_f32 v[34:35], v[34:35], v[38:39]
    v_cvt_pk_bf16_f32 v32, v32, v33
    v_cvt_pk_bf16_f32 v33, v34, v35
    v_mov_b32 v34, s20
    v_mov_b32 v35, s21
    s_lshl_b32 s8, s12, 6
    v_add_u32 v13, s8, v12
    s_mov_b32 exec_lo, 0x00030003
    s_mov_b32 exec_hi, 0x00030003
    global_store_dwordx4 v13, v[32:35], s[4:5] sc1
    s_mov_b64 exec, -1
    s_branch L_front_done
L_cls_d:
    s_waitcnt vmcnt(0)
    v_readfirstlane_b32 s20, v40
    v_readfirstlane_b32 s21, v41
    s_add_u32 s20, s20, 1
    s_and_b32 s98, s20, 0xff
    s_sub_u32 s96, 0, s98
    s_subb_u32 s97, 0, s98
    s_cmp_lg_u32 s22, 3
    s_cbranch_scc1 Lnf_182
    s_xor_b32 s9, s21, s41
    v_mov_b32 v4, s20
    v_mov_b32 v5, s9
    s_lshl_b32 s8, s23, 5
    s_add_u32 s8, s8, s24
    s_lshl_b32 s8, s8, 3
    s_add_u32 s8, s8, 4096
    v_mov_b32 v2, s8
    s_mov_b64 exec, 1
    global_store_dwordx2 v2, v[4:5], s[4:5] sc1
    s_mov_b64 exec, -1
Lnf_182:
    s_cmp_eq_u32 s22, 0
    s_cbranch_scc1 L_front_done
    v_lshrrev_b32 v2, 3, v0
    v_mul_u32_u24 v6, 7680, v2
    v_bfe_u32 v2, v0, 4, 1
    v_lshlrev_b32 v2, 1, v2
    v_and_b32 v3, 7, v0
    v_xor_b32 v2, v2, v3
    v_lshl_add_u32 v6, v2, 4, v6
    s_setprio 0
    s_mul_i32 s10, s27, 61440
    s_add_u32 s6, s6, s10
    s_addc_u32 s7, s7, 0
    s_lshl_b32 s11, s27, 10
    s_add_u32 s11, s11, 8192
    s_mov_b32 s12, s27
Ldma_183:
    s_mov_b32 m0, s11
    s_bitcmp1_b32 s12, 0
    s_cselect_b32 s13, 64, 0
    v_xor_b32 v8, s13, v6
    s_add_u32 s11, s11, 3072
    global_load_lds_dwordx4 v8, s[6:7] nt
    s_add_u32 s6, s6, 184320
    s_addc_u32 s7, s7, 0
    s_add_u32 s12, s12, 3
    s_cmp_lt_u32 s12, 80
    s_cbranch_scc1 Ldma_183
    s_setprio 3
    v_lshlrev_b32 v12, 16, v44
    v_and_b32 v13, 0xffff0000, v44
    v_lshlrev_b32 v14, 16, v45
    v_and_b32 v15, 0xffff0000, v45
    v_lshlrev_b32 v16, 16, v46
    v_and_b32 v17, 0xffff0000, v46
    v_lshlrev_b32 v18, 16, v47
    v_and_b32 v19, 0xffff0000, v47
    s_mov_b32 s8, 0xbfb8aa3b
    s_mov_b32 s9, 0xb2a57060
    s_mov_b32 s10, 0x3f317218
    v_mul_f32 v48, s8, v12
    v_mul_f32 v49, s8, v13
    v_mul_f32 v50, s8, v14
    v_mul_f32 v51, s8, v15
    v_mul_f32 v52, s8, v16
    v_mul_f32 v53, s8, v17
    v_mul_f32 v54, s8, v18
    v_mul_f32 v55, s8, v19
    v_fma_f32 v56, s8, v12, -v48
    v_fma_f32 v57, s8, v13, -v49
    v_fma_f32 v58, s8, v14, -v50
    v_fma_f32 v59, s8, v15, -v51
    v_fma_f32 v60, s8, v16, -v52
    v_fma_f32 v61, s8, v17, -v53
    v_fma_f32 v62, s8, v18, -v54
    v_fma_f32 v63, s8, v19, -v55
    v_fmac_f32 v56, s9, v12
    v_fmac_f32 v57, s9, v13
    v_fmac_f32 v58, s9, v14
    v_fmac_f32 v59, s9, v15
    v_fmac_f32 v60, s9, v16
    v_fmac_f32 v61, s9, v17
    v_fmac_f32 v62, s9, v18
    v_fmac_f32 v63, s9, v19
    v_min_f32 v48, 0x42fc0000, v48
    v_min_f32 v49, 0x42fc0000, v49
    v_min_f32 v50, 0x42fc0000, v50
    v_min_f32 v51, 0x42fc0000, v51
    v_min_f32 v52, 0x42fc0000, v52
    v_min_f32 v53, 0x42fc0000, v53
    v_min_f32 v54, 0x42fc0000, v54
    v_min_f32 v55, 0x42fc0000, v55
    v_exp_f32 v48, v48
    v_exp_f32 v49, v49
    v_exp_f32 v50, v50
    v_exp_f32 v51, v51
    v_exp_f32 v52, v52
    v_exp_f32 v53, v53
    v_exp_f32 v54, v54
    v_exp_f32 v55, v55
    v_mul_f32 v56, s10, v56
    v_mul_f32 v57, s10, v57
    v_mul_f32 v58, s10, v58
    v_mul_f32 v59, s10, v59
    v_mul_f32 v60, s10, v60
    v_mul_f32 v61, s10, v61
    v_mul_f32 v62, s10, v62
    v_mul_f32 v63, s10, v63
    v_fmac_f32 v48, v48, v56
    v_fmac_f32 v49, v49, v57
    v_fmac_f32 v50, v50, v58
    v_fmac_f32 v51, v51, v59
    v_fmac_f32 v52, v52, v60
    v_fmac_f32 v53, v53, v61
    v_fmac_f32 v54, v54, v62
    v_fmac_f32 v55, v55, v63
    v_add_f32 v48, 1.0, v48
    v_add_f32 v49, 1.0, v49
    v_add_f32 v50, 1.0, v50
    v_add_f32 v51, 1.0, v51
    v_add_f32 v52, 1.0, v52
    v_add_f32 v53, 1.0, v53
    v_add_f32 v54, 1.0, v54
    v_add_f32 v55, 1.0, v55
    v_rcp_f32 v56, v48
    v_rcp_f32 v57, v49
    v_rcp_f32 v58, v50
    v_rcp_f32 v59, v51
    v_rcp_f32 v60, v52
    v_rcp_f32 v61, v53
    v_rcp_f32 v62, v54
    v_rcp_f32 v63, v55
    v_mul_f32 v44, v12, v56
    v_fma_f32 v48, -v44, v48, v12
    v_fma_f32 v12, v48, v56, v44
    v_mul_f32 v45, v13, v57
    v_fma_f32 v49, -v45, v49, v13
    v_fma_f32 v13, v49, v57, v45
    v_mul_f32 v46, v14, v58
    v_fma_f32 v50, -v46, v50, v14
    v_fma_f32 v14, v50, v58, v46
    v_mul_f32 v47, v15, v59
    v_fma_f32 v51, -v47, v51, v15
    v_fma_f32 v15, v51, v59, v47
    v_mul_f32 v44, v16, v60
    v_fma_f32 v52, -v44, v52, v16
    v_fma_f32 v16, v52, v60, v44
    v_mul_f32 v45, v17, v61
    v_fma_f32 v53, -v45, v53, v17
    v_fma_f32 v17, v53, v61, v45
    v_mul_f32 v46, v18, v62
    v_fma_f32 v54, -v46, v54, v18
    v_fma_f32 v18, v54, v62, v46
    v_mul_f32 v47, v19, v63
    v_fma_f32 v55, -v47, v55, v19
    v_fma_f32 v19, v55, v63, v47
    v_cvt_pk_bf16_f32 v44, v12, v13
    v_cvt_pk_bf16_f32 v45, v14, v15
    v_cvt_pk_bf16_f32 v46, v16, v17
    v_cvt_pk_bf16_f32 v47, v18, v19
    ds_write_b128 v10, v[44:47] offset:1024
    s_waitcnt lgkmcnt(0)
    v_mov_b32 v2, 1
    s_mov_b64 s[16:17], exec
    s_mov_b64 exec, 1
    ds_add_u32 v1, v2 offset:20
    s_mov_b64 exec, s[16:17]
    v_lshrrev_b32 v2, 4, v0
    v_lshlrev_b32 v9, 10, v2
    v_bfe_u32 v2, v0, 2, 2
    v_lshl_add_u32 v9, v2, 7, v9
    v_bfe_u32 v2, v0, 3, 2
    v_lshl_add_u32 v9, v2, 5, v9
    v_and_b32 v2, 3, v0
    v_lshl_add_u32 v9, v2, 3, v9
    v_add_u32 v9, 8192, v9
    v_and_b32 v2, 1, v0
    v_mul_u32_u24 v11, 1280, v2
    v_lshrrev_b32 v2, 4, v0
    v_lshl_add_u32 v11, v2, 4, v11
    v_and_b32 v2, 1, v0
    v_lshlrev_b32 v12, 8, v2
    v_lshrrev_b32 v2, 4, v0
    v_lshl_add_u32 v12, v2, 4, v12
    s_lshl_b32 s8, s37, 9
    s_add_u32 s8, s8, 8192
    v_add_u32 v12, s8, v12
    s_mov_b32 s19, 33
    s_mov_b32 s18, 0
Llds_184:
    ds_read_b32 v2, v1 offset:20
    s_add_u32 s18, s18, 1
    s_cmp_gt_u32 s18, 400000
    s_cbranch_scc1 L_fail
    s_waitcnt lgkmcnt(0)
    v_readfirstlane_b32 s8, v2
    s_cmp_lt_u32 s8, 3
    s_cbranch_scc1 Llds_184
    ds_read_b128 v[80:83], v11 offset:1024
    ds_read_b128 v[84:87], v11 offset:1088
    ds_read_b128 v[88:91], v11 offset:1152
    ds_read_b128 v[92:95], v11 offset:1216
    ds_read_b128 v[96:99], v11 offset:1280
    ds_read_b128 v[100:103], v11 offset:1344
    ds_read_b128 v[104:107], v11 offset:1408
    ds_read_b128 v[108:111], v11 offset:1472
    ds_read_b128 v[112:115], v11 offset:1536
    ds_read_b128 v[116:119], v11 offset:1600
    ds_read_b128 v[120:123], v11 offset:1664
    ds_read_b128 v[124:127], v11 offset:1728
    ds_read_b128 v[128:131], v11 offset:1792
    ds_read_b128 v[132:135], v11 offset:1856
    ds_read_b128 v[136:139], v11 offset:1920
    ds_read_b128 v[140:143], v11 offset:1984
    ds_read_b128 v[144:147], v11 offset:2048
    ds_read_b128 v[148:151], v11 offset:2112
    ds_read_b128 v[152:155], v11 offset:2176
    ds_read_b128 v[156:159], v11 offset:2240
    s_waitcnt vmcnt(0)
    v_mov_b32 v2, 1
    s_mov_b64 s[16:17], exec
    s_mov_b64 exec, 1
    ds_add_u32 v1, v2 offset:0
    s_mov_b64 exec, s[16:17]
    s_mov_b32 s19, 32
    s_mov_b32 s18, 0
Llds_185:
    ds_read_b32 v2, v1 offset:0
    s_add_u32 s18, s18, 1
    s_cmp_gt_u32 s18, 400000
    s_cbranch_scc1 L_fail
    s_waitcnt lgkmcnt(0)
    v_readfirstlane_b32 s8, v2
    s_cmp_lt_u32 s8, 3
    s_cbranch_scc1 Llds_185
    s_mov_b32 s12, s27
Lmb_186:
    s_lshl_b32 s8, s12, 5
    v_xor_b32 v13, s8, v9
    v_add_u32 v10, 40960, v13
    ds_read_b64_tr_b16 v[40:41], v13 offset:0
    ds_read_b64_tr_b16 v[42:43], v13 offset:512
    ds_read_b64_tr_b16 v[44:45], v13 offset:4096
    ds_read_b64_tr_b16 v[46:47], v13 offset:4608
    ds_read_b64_tr_b16 v[48:49], v13 offset:8192
    ds_read_b64_tr_b16 v[50:51], v13 offset:8704
    ds_read_b64_tr_b16 v[52:53], v13 offset:12288
    ds_read_b64_tr_b16 v[54:55], v13 offset:12800
    ds_read_b64_tr_b16 v[56:57], v13 offset:16384
    ds_read_b64_tr_b16 v[58:59], v13 offset:16896
    ds_read_b64_tr_b16 v[60:61], v13 offset:20480
    ds_read_b64_tr_b16 v[62:63], v13 offset:20992
    ds_read_b64_tr_b16 v[64:65], v13 offset:24576
    ds_read_b64_tr_b16 v[66:67], v13 offset:25088
    ds_read_b64_tr_b16 v[68:69], v13 offset:28672
    ds_read_b64_tr_b16 v[70:71], v13 offset:29184
    ds_read_b64_tr_b16 v[72:73], v13 offset:32768
    ds_read_b64_tr_b16 v[74:75], v13 offset:33280
    ds_read_b64_tr_b16 v[76:77], v13 offset:36864
    ds_read_b64_tr_b16 v[78:79], v13 offset:37376
    s_waitcnt lgkmcnt(10)
    v_mfma_f32_16x16x32_bf16 v[32:35], v[40:43], v[80:83], 0
    v_mfma_f32_16x16x32_bf16 v[36:39], v[44:47], v[84:87], 0
    v_mfma_f32_16x16x32_bf16 v[32:35], v[48:51], v[88:91], v[32:35]
    v_mfma_f32_16x16x32_bf16 v[36:39], v[52:55], v[92:95], v[36:39]
    v_mfma_f32_16x16x32_bf16 v[32:35], v[56:59], v[96:99], v[32:35]
    ds_read_b64_tr_b16 v[40:41], v10 offset:0
    ds_read_b64_tr_b16 v[42:43], v10 offset:512
    ds_read_b64_tr_b16 v[44:45], v10 offset:4096
    ds_read_b64_tr_b16 v[46:47], v10 offset:4608
    ds_read_b64_tr_b16 v[48:49], v10 offset:8192
    ds_read_b64_tr_b16 v[50:51], v10 offset:8704
    ds_read_b64_tr_b16 v[52:53], v10 offset:12288
    ds_read_b64_tr_b16 v[54:55], v10 offset:12800
    ds_read_b64_tr_b16 v[56:57], v10 offset:16384
    ds_read_b64_tr_b16 v[58:59], v10 offset:16896
    s_waitcnt lgkmcnt(10)
    v_mfma_f32_16x16x32_bf16 v[36:39], v[60:63], v[100:103], v[36:39]
    v_mfma_f32_16x16x32_bf16 v[32:35], v[64:67], v[104:107], v[32:35]
    v_mfma_f32_16x16x32_bf16 v[36:39], v[68:71], v[108:111], v[36:39]
    v_mfma_f32_16x16x32_bf16 v[32:35], v[72:75], v[112:115], v[32:35]
    v_mfma_f32_16x16x32_bf16 v[36:39], v[76:79], v[116:119], v[36:39]
    ds_read_b64_tr_b16 v[60:61], v10 offset:20480
    ds_read_b64_tr_b16 v[62:63], v10 offset:20992
    ds_read_b64_tr_b16 v[64:65], v10 offset:24576
    ds_read_b64_tr_b16 v[66:67], v10 offset:25088
    ds_read_b64_tr_b16 v[68:69], v10 offset:28672
    ds_read_b64_tr_b16 v[70:71], v10 offset:29184
    ds_read_b64_tr_b16 v[72:73], v10 offset:32768
    ds_read_b64_tr_b16 v[74:75], v10 offset:33280
    ds_read_b64_tr_b16 v[76:77], v10 offset:36864
    ds_read_b64_tr_b16 v[78:79], v10 offset:37376
    s_waitcnt lgkmcnt(10)
    v_mfma_f32_16x16x32_bf16 v[32:35], v[40:43], v[120:123], v[32:35]
    v_mfma_f32_16x16x32_bf16 v[36:39], v[44:47], v[124:127], v[36:39]
    v_mfma_f32_16x16x32_bf16 v[32:35], v[48:51], v[128:131], v[32:35]
    v_mfma_f32_16x16x32_bf16 v[36:39], v[52:55], v[132:135], v[36:39]
    v_mfma_f32_16x16x32_bf16 v[32:35], v[56:59], v[136:139], v[32:35]
    s_waitcnt lgkmcnt(0)
    v_mfma_f32_16x16x32_bf16 v[36:39], v[60:63], v[140:143], v[36:39]
    v_mfma_f32_16x16x32_bf16 v[32:35], v[64:67], v[144:147], v[32:35]
    v_mfma_f32_16x16x32_bf16 v[36:39], v[68:71], v[148:151], v[36:39]
    v_mfma_f32_16x16x32_bf16 v[32:35], v[72:75], v[152:155], v[32:35]
    v_mfma_f32_16x16x32_bf16 v[36:39], v[76:79], v[156:159], v[36:39]
    s_nop 7
    v_pk_add_f32 v[32:33], v[32:33], v[36:37]
    v_pk_add_f32 v[34:35], v[34:35], v[38:39]
    v_cvt_pk_bf16_f32 v32, v32, v33
    v_cvt_pk_bf16_f32 v33, v34, v35
    v_mov_b32 v34, s20
    v_mov_b32 v35, s21
    s_lshl_b32 s8, s12, 6
    v_add_u32 v13, s8, v12
    s_mov_b32 exec_lo, 0x00030003
    s_mov_b32 exec_hi, 0x00030003
    global_store_dwordx4 v13, v[32:35], s[4:5] sc1
    s_mov_b64 exec, -1
    s_add_u32 s12, s12, 3
    s_cmp_lt_u32 s12, 4
    s_cbranch_scc1 Lmb_186
    s_branch L_front_done
L_cls_n:
    s_cmp_eq_u32 s22, 3
    s_cbranch_scc1 L_cls_n3
    s_cmp_lt_u32 s24, 12
    s_cbranch_scc1 Lnowo_187
    s_lshl_b32 s8, s23, 1
    s_and_b32 s9, s24, 1
    s_add_u32 s8, s8, s9
    s_mul_i32 s8, s8, 327680
    s_sub_u32 s9, s24, 12
    s_lshr_b32 s9, s9, 1
    s_lshl_b32 s9, s9, 7
    s_add_u32 s8, s8, s9
    s_add_u32 s30, s30, s8
    s_addc_u32 s31, s31, 0
    v_lshrrev_b32 v2, 3, v0
    v_mul_u32_u24 v7, 1280, v2
    v_bfe_u32 v2, v0, 4, 1
    v_lshlrev_b32 v2, 1, v2
    v_and_b32 v3, 7, v0
    v_xor_b32 v2, v2, v3
    v_lshl_add_u32 v7, v2, 4, v7
    s_setprio 0
    s_mul_i32 s10, s22, 10240
    s_add_u32 s30, s30, s10
    s_addc_u32 s31, s31, 0
    s_lshl_b32 s11, s22, 10
    s_add_u32 s11, s11, 90112
    s_mov_b32 s12, s22
Ldma_188:
    s_mov_b32 m0, s11
    s_bitcmp1_b32 s12, 0
    s_cselect_b32 s13, 64, 0
    v_xor_b32 v8, s13, v7
    s_add_u32 s11, s11, 3072
    global_load_lds_dwordx4 v8, s[30:31] nt
    s_add_u32 s30, s30, 30720
    s_addc_u32 s31, s31, 0
    s_add_u32 s12, s12, 3
    s_cmp_lt_u32 s12, 32
    s_cbranch_scc1 Ldma_188
    s_setprio 3
Lnowo_187:
L_cls_n3:
    s_waitcnt vmcnt(0)
    v_readfirstlane_b32 s20, v40
    v_readfirstlane_b32 s21, v41
    s_add_u32 s20, s20, 1
    s_and_b32 s98, s20, 0xff
    s_sub_u32 s96, 0, s98
    s_subb_u32 s97, 0, s98
    s_cmp_lg_u32 s22, 3
    s_cbranch_scc1 Lnf_189
    s_xor_b32 s9, s21, s41
    v_mov_b32 v4, s20
    v_mov_b32 v5, s9
    s_lshl_b32 s8, s23, 5
    s_add_u32 s8, s8, s24
    s_lshl_b32 s8, s8, 3
    s_add_u32 s8, s8, 4096
    v_mov_b32 v2, s8
    s_mov_b64 exec, 1
    global_store_dwordx2 v2, v[4:5], s[4:5] sc1
    s_mov_b64 exec, -1
Lnf_189:
    s_cmp_eq_u32 s22, 0
    s_cbranch_scc1 L_front_done
    s_branch L_wo_late
L_cls_q:
    s_cmp_eq_u32 s22, 3
    s_cbranch_scc1 L_q_h3
    s_add_u32 s28, s28, s14
    s_addc_u32 s29, s29, 0
    v_lshrrev_b32 v2, 4, v0
    v_mul_u32_u24 v6, 8192, v2
    v_lshlrev_b32 v2, 1, v2
    v_and_b32 v3, 15, v0
    v_xor_b32 v2, v2, v3
    v_lshl_add_u32 v6, v2, 4, v6
    s_setprio 0
    s_mul_i32 s10, s22, 32768
    s_add_u32 s28, s28, s10
    s_addc_u32 s29, s29, 0
    s_lshl_b32 s11, s22, 10
    s_add_u32 s11, s11, 57344
    s_mov_b32 s12, s22
Ldma_190:
    s_mov_b32 m0, s11
    s_bitcmp1_b32 s12, 1
    s_cselect_b32 s13, 128, 0
    v_xor_b32 v8, s13, v6
    s_add_u32 s11, s11, 3072
    global_load_lds_dwordx4 v8, s[28:29] nt
    s_add_u32 s28, s28, 98304
    s_addc_u32 s29, s29, 0
    s_add_u32 s12, s12, 3
    s_cmp_lt_u32 s12, 32
    s_cbranch_scc1 Ldma_190
    s_setprio 3
    s_cmp_lt_u32 s24, 12
    s_cbranch_scc1 Lnowo_191
    s_lshl_b32 s8, s23, 1
    s_and_b32 s9, s24, 1
    s_add_u32 s8, s8, s9
    s_mul_i32 s8, s8, 327680
    s_sub_u32 s9, s24, 12
    s_lshr_b32 s9, s9, 1
    s_lshl_b32 s9, s9, 7
    s_add_u32 s8, s8, s9
    s_add_u32 s30, s30, s8
    s_addc_u32 s31, s31, 0
    v_lshrrev_b32 v2, 3, v0
    v_mul_u32_u24 v7, 1280, v2
    v_bfe_u32 v2, v0, 4, 1
    v_lshlrev_b32 v2, 1, v2
    v_and_b32 v3, 7, v0
    v_xor_b32 v2, v2, v3
    v_lshl_add_u32 v7, v2, 4, v7
    s_setprio 0
    s_mul_i32 s10, s22, 10240
    s_add_u32 s30, s30, s10
    s_addc_u32 s31, s31, 0
    s_lshl_b32 s11, s22, 10
    s_add_u32 s11, s11, 90112
    s_mov_b32 s12, s22
Ldma_192:
    s_mov_b32 m0, s11
    s_bitcmp1_b32 s12, 0
    s_cselect_b32 s13, 64, 0
    v_xor_b32 v8, s13, v7
    s_add_u32 s11, s11, 3072
    global_load_lds_dwordx4 v8, s[30:31] nt
    s_add_u32 s30, s30, 30720
    s_addc_u32 s31, s31, 0
    s_add_u32 s12, s12, 3
    s_cmp_lt_u32 s12, 32
    s_cbranch_scc1 Ldma_192
    s_setprio 3
Lnowo_191:
    s_cmp_lt_u32 s24, 12
    s_cbranch_scc1 Lwqw_193
    s_waitcnt vmcnt(10)
    s_branch Lwqw_193_j
Lwqw_193:
    s_waitcnt vmcnt(0)
Lwqw_193_j:
    v_mov_b32 v2, 1
    s_mov_b64 s[16:17], exec
    s_mov_b64 exec, 1
    ds_add_u32 v1, v2 offset:4
    s_mov_b64 exec, s[16:17]
    v_readfirstlane_b32 s20, v40
    v_readfirstlane_b32 s21, v41
    s_add_u32 s20, s20, 1
    s_and_b32 s98, s20, 0xff
    s_sub_u32 s96, 0, s98
    s_subb_u32 s97, 0, s98
    s_cmp_lg_u32 s22, 0
    s_cbranch_scc1 L_q_compute
    v_and_b32 v2, 31, v0
    v_lshlrev_b32 v2, 3, v2
    s_lshl_b32 s8, s23, 8
    s_add_u32 s8, s8, 4096
    v_add_u32 v2, s8, v2
    s_mov_b32 s19, 0x50
    s_mov_b32 s18, 0
    s_branch Lgmf_195
Lgm_194:
    s_sleep 1
Lgmf_195:
    global_load_dwordx2 v[40:41], v2, s[4:5] sc1
    s_add_u32 s18, s18, 1
    s_cmp_gt_u32 s18, 40000
    s_cbranch_scc1 L_fail
    s_waitcnt vmcnt(0)
    v_xor_b32 v40, s20, v40
    v_xor_b32 v41, s21, v41
    v_lshrrev_b32 v3, 4, v41
    v_or_b32 v3, v40, v3
    v_cmp_ne_u32 vcc, 0, v3
    s_cbranch_vccnz Lgm_194
    v_cmp_ne_u32 vcc, s41, v41
    s_cmp_eq_u64 vcc, 0
    s_cselect_b32 s40, 1, 2
    s_lshl_b32 s8, s98, 8
    s_or_b32 s8, s8, s40
    v_mov_b32 v3, s8
    ds_write_b32 v1, v3 offset:16
    s_branch L_q_compute
L_q_h3:
    s_waitcnt vmcnt(0)
    v_readfirstlane_b32 s20, v40
    v_readfirstlane_b32 s21, v41
    s_add_u32 s20, s20, 1
    s_and_b32 s98, s20, 0xff
    s_sub_u32 s96, 0, s98
    s_subb_u32 s97, 0, s98
    s_cmp_lg_u32 s22, 3
    s_cbranch_scc1 Lnf_196
    s_xor_b32 s9, s21, s41
    v_mov_b32 v4, s20
    v_mov_b32 v5, s9
    s_lshl_b32 s8, s23, 5
    s_add_u32 s8, s8, s24
    s_lshl_b32 s8, s8, 3
    s_add_u32 s8, s8, 4096
    v_mov_b32 v2, s8
    s_mov_b64 exec, 1
    global_store_dwordx2 v2, v[4:5], s[4:5] sc1
    s_mov_b64 exec, -1
Lnf_196:
    v_mov_b32 v2, 0x3f803f80
    v_mov_b32 v34, 0
    v_mov_b32 v35, 0
    v_dot2c_f32_bf16 v34, v24, v2
    v_dot2c_f32_bf16 v35, v24, v24
    v_dot2c_f32_bf16 v34, v25, v2
    v_dot2c_f32_bf16 v35, v25, v25
    v_dot2c_f32_bf16 v34, v26, v2
    v_dot2c_f32_bf16 v35, v26, v26
    v_dot2c_f32_bf16 v34, v27, v2
    v_dot2c_f32_bf16 v35, v27, v27
    v_dot2c_f32_bf16 v34, v28, v2
    v_dot2c_f32_bf16 v35, v28, v28
    v_dot2c_f32_bf16 v34, v29, v2
    v_dot2c_f32_bf16 v35, v29, v29
    v_dot2c_f32_bf16 v34, v30, v2
    v_dot2c_f32_bf16 v35, v30, v30
    v_dot2c_f32_bf16 v34, v31, v2
    v_dot2c_f32_bf16 v35, v31, v31
    v_dot2c_f32_bf16 v34, v32, v2
    v_dot2c_f32_bf16 v35, v32, v32
    v_dot2c_f32_bf16 v34, v33, v2
    v_dot2c_f32_bf16 v35, v33, v33
    s_nop 1
    v_add_f32_dpp v34, v34, v34 quad_perm:[1,0,3,2] row_mask:0xf bank_mask:0xf
    v_add_f32_dpp v35, v35, v35 quad_perm:[1,0,3,2] row_mask:0xf bank_mask:0xf
    s_nop 0
    v_add_f32_dpp v34, v34, v34 quad_perm:[2,3,0,1] row_mask:0xf bank_mask:0xf
    v_add_f32_dpp v35, v35, v35 quad_perm:[2,3,0,1] row_mask:0xf bank_mask:0xf
    s_nop 0
    v_add_f32_dpp v34, v34, v34 row_half_mirror row_mask:0xf bank_mask:0xf
    v_add_f32_dpp v35, v35, v35 row_half_mirror row_mask:0xf bank_mask:0xf
    s_nop 0
    v_add_f32_dpp v34, v34, v34 row_mirror row_mask:0xf bank_mask:0xf
    v_add_f32_dpp v35, v35, v35 row_mirror row_mask:0xf bank_mask:0xf
    v_mov_b32 v2, v34
    v_mov_b32 v3, v35
    s_nop 0
    v_permlane16_swap_b32 v34, v2
    v_permlane16_swap_b32 v35, v3
    v_add_f32 v34, v34, v2
    v_add_f32 v35, v35, v3
    v_mul_f32 v34, 0x3acccccd, v34
    v_mul_f32 v35, 0x3acccccd, v35
    v_fma_f32 v35, -v34, v34, v35
    v_max_f32 v35, 0, v35
    v_cvt_pk_bf16_f32 v2, v34, v35
    v_lshlrev_b32 v34, 16, v2
    v_and_b32 v35, 0xffff0000, v2
    v_add_f32 v35, 0x3727c5ac, v35
    v_cvt_pk_bf16_f32 v35, v35, v35
    v_and_b32 v35, 0xffff0000, v35
    v_sqrt_f32 v35, v35
    s_nop 0
    v_cvt_pk_bf16_f32 v35, v35, v35
    v_and_b32 v35, 0xffff0000, v35
    v_rcp_f32 v35, v35
    v_lshlrev_b32 v36, 16, v24
    v_and_b32 v37, 0xffff0000, v24
    v_lshlrev_b32 v38, 16, v25
    v_and_b32 v39, 0xffff0000, v25
    v_sub_f32 v36, v36, v34
    v_sub_f32 v37, v37, v34
    v_sub_f32 v38, v38, v34
    v_sub_f32 v39, v39, v34
    v_cvt_pk_bf16_f32 v2, v36, v37
    v_cvt_pk_bf16_f32 v3, v38, v39
    v_lshlrev_b32 v36, 16, v2
    v_and_b32 v37, 0xffff0000, v2
    v_lshlrev_b32 v38, 16, v3
    v_and_b32 v39, 0xffff0000, v3
    v_mul_f32 v36, v36, v35
    v_mul_f32 v37, v37, v35
    v_mul_f32 v38, v38, v35
    v_mul_f32 v39, v39, v35
    v_cvt_pk_bf16_f32 v2, v36, v37
    v_cvt_pk_bf16_f32 v3, v38, v39
    v_lshlrev_b32 v36, 16, v2
    v_and_b32 v37, 0xffff0000, v2
    v_lshlrev_b32 v38, 16, v3
    v_and_b32 v39, 0xffff0000, v3
    v_bfe_u32 v2, v0, 4, 1
    v_lshlrev_b32 v16, 9, v2
    v_lshrrev_b32 v2, 5, v0
    v_lshl_add_u32 v16, v2, 8, v16
    v_and_b32 v2, 15, v0
    v_lshl_add_u32 v16, v2, 4, v16
    s_lshl_b32 s8, s26, 10
    s_add_u32 s8, s8, 8192
    v_add_u32 v16, s8, v16
    v_add_u32 v17, 5120, v16
    s_mov_b32 s19, 49
    s_mov_b32 s18, 0
    s_branch Lgtf_198
Lgt_197:
    s_sleep 30
Lgtf_198:
    global_load_dwordx4 v[48:51], v16, s[4:5] sc1
    global_load_dwordx4 v[52:55], v17, s[4:5] sc1
    s_add_u32 s18, s18, 1
    s_cmp_gt_u32 s18, 40000
    s_cbranch_scc1 L_fail
    s_waitcnt vmcnt(0)
    v_xor_b32 v50, s20, v50
    v_xor_b32 v51, s21, v51
    v_or_b32 v2, v50, v51
    v_xor_b32 v54, s20, v54
    v_xor_b32 v55, s21, v55
    v_or3_b32 v2, v2, v54, v55
    v_cmp_ne_u32 vcc, 0, v2
    s_cbranch_vccnz Lgt_197
    v_lshlrev_b32 v56, 16, v48
    v_and_b32 v57, 0xffff0000, v48
    v_lshlrev_b32 v58, 16, v49
    v_and_b32 v59, 0xffff0000, v49
    v_lshlrev_b32 v60, 16, v52
    v_and_b32 v61, 0xffff0000, v52
    v_lshlrev_b32 v62, 16, v53
    v_and_b32 v63, 0xffff0000, v53
    v_add_f32 v60, 1.0, v60
    v_add_f32 v61, 1.0, v61
    v_add_f32 v62, 1.0, v62
    v_add_f32 v63, 1.0, v63
    v_cvt_pk_bf16_f32 v2, v60, v61
    v_cvt_pk_bf16_f32 v3, v62, v63
    v_lshlrev_b32 v60, 16, v2
    v_and_b32 v61, 0xffff0000, v2
    v_lshlrev_b32 v62, 16, v3
    v_and_b32 v63, 0xffff0000, v3
    v_mul_f32 v36, v36, v60
    v_mul_f32 v37, v37, v61
    v_mul_f32 v38, v38, v62
    v_mul_f32 v39, v39, v63
    v_cvt_pk_bf16_f32 v2, v36, v37
    v_cvt_pk_bf16_f32 v3, v38, v39
    v_lshlrev_b32 v36, 16, v2
    v_and_b32 v37, 0xffff0000, v2
    v_lshlrev_b32 v38, 16, v3
    v_and_b32 v39, 0xffff0000, v3
    v_add_f32 v36, v36, v56
    v_add_f32 v37, v37, v57
    v_add_f32 v38, v38, v58
    v_add_f32 v39, v39, v59
    v_cvt_pk_bf16_f32 v2, v36, v37
    v_cvt_pk_bf16_f32 v3, v38, v39
    v_lshrrev_b32 v4, 5, v0
    v_lshlrev_b32 v4, 8, v4
    v_and_b32 v5, 31, v0
    v_lshl_add_u32 v4, v5, 3, v4
    ds_write_b64 v4, v[2:3] offset:3584
    s_waitcnt lgkmcnt(0)
    v_mov_b32 v2, 1
    s_mov_b64 s[16:17], exec
    s_mov_b64 exec, 1
    ds_add_u32 v1, v2 offset:8
    s_mov_b64 exec, s[16:17]
L_q_compute:
    s_mov_b32 s19, 64
    s_mov_b32 s18, 0
Llds_199:
    ds_read_b32 v2, v1 offset:4
    s_add_u32 s18, s18, 1
    s_cmp_gt_u32 s18, 400000
    s_cbranch_scc1 L_fail
    s_waitcnt lgkmcnt(0)
    v_readfirstlane_b32 s8, v2
    s_cmp_lt_u32 s8, 3
    s_cbranch_scc1 Llds_199
    v_lshrrev_b32 v2, 4, v0
    v_lshlrev_b32 v8, 11, v2
    v_bfe_u32 v2, v0, 2, 2
    v_lshl_add_u32 v8, v2, 8, v8
    v_lshl_add_u32 v8, v2, 5, v8
    v_bfe_u32 v2, v0, 4, 1
    v_lshl_add_u32 v8, v2, 7, v8
    v_and_b32 v2, 3, v0
    v_lshl_add_u32 v8, v2, 3, v8
    s_lshl_b32 s8, s22, 6
    v_xor_b32 v8, s8, v8
    v_add_u32 v8, 57344, v8
    v_xor_b32 v11, 32, v8
    ds_read_b64_tr_b16 v[80:81], v8 offset:0
    ds_read_b64_tr_b16 v[82:83], v8 offset:1024
    ds_read_b64_tr_b16 v[84:85], v8 offset:8192
    ds_read_b64_tr_b16 v[86:87], v8 offset:9216
    ds_read_b64_tr_b16 v[88:89], v8 offset:16384
    ds_read_b64_tr_b16 v[90:91], v8 offset:17408
    ds_read_b64_tr_b16 v[92:93], v8 offset:24576
    ds_read_b64_tr_b16 v[94:95], v8 offset:25600
    ds_read_b64_tr_b16 v[96:97], v11 offset:0
    ds_read_b64_tr_b16 v[98:99], v11 offset:1024
    ds_read_b64_tr_b16 v[100:101], v11 offset:8192
    ds_read_b64_tr_b16 v[102:103], v11 offset:9216
    ds_read_b64_tr_b16 v[104:105], v11 offset:16384
    ds_read_b64_tr_b16 v[106:107], v11 offset:17408
    ds_read_b64_tr_b16 v[108:109], v11 offset:24576
    ds_read_b64_tr_b16 v[110:111], v11 offset:25600
    v_and_b32 v2, 1, v0
    v_mul_u32_u24 v9, 256, v2
    v_lshrrev_b32 v2, 4, v0
    v_lshl_add_u32 v9, v2, 4, v9
    v_and_b32 v2, 1, v0
    v_lshlrev_b32 v10, 9, v2
    v_lshrrev_b32 v2, 4, v0
    v_lshl_add_u32 v10, v2, 4, v10
    s_lshl_b32 s9, s22, 7
    s_add_u32 s8, s25, s9
    s_add_u32 s8, s8, 0
    v_add_u32 v10, s8, v10
    s_mov_b32 s19, 66
    s_mov_b32 s18, 0
Llds_200:
    ds_read_b32 v2, v1 offset:16
    s_add_u32 s18, s18, 1
    s_cmp_gt_u32 s18, 400000
    s_cbranch_scc1 L_fail
    s_waitcnt lgkmcnt(0)
    v_readfirstlane_b32 s8, v2
    s_cmp_lt_u32 s8, 1
    s_cbranch_scc1 Llds_200
    s_and_b32 s40, s8, 3
    s_mov_b32 s19, 65
    s_mov_b32 s18, 0
Llds_201:
    ds_read_b32 v2, v1 offset:8
    s_add_u32 s18, s18, 1
    s_cmp_gt_u32 s18, 400000
    s_cbranch_scc1 L_fail
    s_waitcnt lgkmcnt(0)
    v_readfirstlane_b32 s8, v2
    s_cmp_lt_u32 s8, 1
    s_cbranch_scc1 Llds_201
    ds_read_b128 v[112:115], v9 offset:3584
    ds_read_b128 v[116:119], v9 offset:3648
    ds_read_b128 v[120:123], v9 offset:3712
    ds_read_b128 v[124:127], v9 offset:3776
    s_waitcnt lgkmcnt(0)
    v_mfma_f32_16x16x32_bf16 v[128:131], v[80:83], v[112:115], 0
    v_mfma_f32_16x16x32_bf16 v[132:135], v[96:99], v[112:115], 0
    v_mfma_f32_16x16x32_bf16 v[128:131], v[84:87], v[116:119], v[128:131]
    v_mfma_f32_16x16x32_bf16 v[132:135], v[100:103], v[116:119], v[132:135]
    v_mfma_f32_16x16x32_bf16 v[128:131], v[88:91], v[120:123], v[128:131]
    v_mfma_f32_16x16x32_bf16 v[132:135], v[104:107], v[120:123], v[132:135]
    v_mfma_f32_16x16x32_bf16 v[128:131], v[92:95], v[124:127], v[128:131]
    v_mfma_f32_16x16x32_bf16 v[132:135], v[108:111], v[124:127], v[132:135]
    s_nop 6
    v_mov_b32_sdwa v128, s20 dst_sel:BYTE_0 dst_unused:UNUSED_PRESERVE src0_sel:BYTE_0
    v_mov_b32_sdwa v129, s20 dst_sel:BYTE_0 dst_unused:UNUSED_PRESERVE src0_sel:BYTE_0
    v_mov_b32_sdwa v130, s20 dst_sel:BYTE_0 dst_unused:UNUSED_PRESERVE src0_sel:BYTE_0
    v_mov_b32_sdwa v131, s20 dst_sel:BYTE_0 dst_unused:UNUSED_PRESERVE src0_sel:BYTE_0
    v_mov_b32_sdwa v132, s20 dst_sel:BYTE_0 dst_unused:UNUSED_PRESERVE src0_sel:BYTE_0
    v_mov_b32_sdwa v133, s20 dst_sel:BYTE_0 dst_unused:UNUSED_PRESERVE src0_sel:BYTE_0
    v_mov_b32_sdwa v134, s20 dst_sel:BYTE_0 dst_unused:UNUSED_PRESERVE src0_sel:BYTE_0
    v_mov_b32_sdwa v135, s20 dst_sel:BYTE_0 dst_unused:UNUSED_PRESERVE src0_sel:BYTE_0
    s_mov_b32 exec_lo, 0x00030003
    s_mov_b32 exec_hi, 0x00030003
    s_cmp_eq_u32 s40, 1
    s_cbranch_scc0 Lg_202
    global_store_dwordx4 v10, v[128:131], s[4:5]
    global_store_dwordx4 v10, v[132:135], s[4:5] offset:64
Lj_203:
    s_mov_b64 exec, -1
    s_cmp_eq_u32 s22, 0
    s_cbranch_scc1 L_h0_main
L_wo_late:
    s_waitcnt vmcnt(0)
L_front_done:
    s_cmp_eq_u32 s22, 0
    s_cbranch_scc1 L_h0_mode
    s_cmp_lg_u32 s22, 1
    s_cbranch_scc1 L_h23
    s_mov_b32 s19, 112
    s_mov_b32 s18, 0
    s_branch Lldsf_205
Llds_204:
    s_sleep 2
Lldsf_205:
    ds_read_b32 v2, v1 offset:16
    s_add_u32 s18, s18, 1
    s_cmp_gt_u32 s18, 400000
    s_cbranch_scc1 L_fail
    s_waitcnt lgkmcnt(0)
    v_readfirstlane_b32 s8, v2
    s_cmp_lt_u32 s8, 1
    s_cbranch_scc1 Llds_204
    s_and_b32 s40, s8, 3
    s_and_b32 s8, s24, 1
    s_lshl_b32 s8, s8, 1
    s_add_u32 s8, s8, 1
    s_mul_i32 s8, s8, 12544
    s_add_u32 s8, s8, s42
    s_add_u32 s8, s8, 3584
    v_lshrrev_b32 v2, 5, v0
    v_mul_u32_u24 v3, 6272, v2
    v_and_b32 v4, 31, v0
    v_lshl_add_u32 v3, v4, 4, v3
    v_add_u32 v40, s8, v3
    s_add_u32 s8, s8, 50176
    v_add_u32 v41, s8, v3
    s_add_u32 s8, s8, 50176
    v_add_u32 v42, s8, v3
    s_add_u32 s8, s8, 50176
    v_add_u32 v43, s8, v3
    v_lshlrev_b32 v10, 9, v2
    v_lshl_add_u32 v10, v4, 3, v10
    v_lshrrev_b32 v2, 5, v0
    v_lshlrev_b32 v2, 11, v2
    v_and_b32 v3, 31, v0
    v_lshl_add_u32 v12, v3, 4, v2
    s_add_u32 s8, s25, 3584
    v_lshlrev_b32 v3, 4, v3
    v_add_u32 v13, s8, v3
    v_lshrrev_b32 v2, 5, v0
    v_lshl_add_u32 v13, v2, 3, v13
    s_barrier
    ds_read_b128 v[16:19], v12 offset:4096
    ds_read_b128 v[20:23], v12 offset:4608
    ds_read_b128 v[24:27], v12 offset:5120
    ds_read_b128 v[28:31], v12 offset:5632
    s_waitcnt lgkmcnt(0)
    v_pk_add_f32 v[16:17], v[16:17], v[20:21]
    v_pk_add_f32 v[18:19], v[18:19], v[22:23]
    v_pk_add_f32 v[16:17], v[16:17], v[24:25]
    v_pk_add_f32 v[18:19], v[18:19], v[26:27]
    v_pk_add_f32 v[16:17], v[16:17], v[28:29]
    v_pk_add_f32 v[18:19], v[18:19], v[30:31]
    s_nop 1
    v_permlane32_swap_b32 v17, v19
    v_permlane32_swap_b32 v16, v18
    v_pk_add_f32 v[16:17], v[16:17], v[18:19]
    v_mov_b32_sdwa v16, s20 dst_sel:BYTE_0 dst_unused:UNUSED_PRESERVE src0_sel:BYTE_0
    v_mov_b32_sdwa v17, s20 dst_sel:BYTE_0 dst_unused:UNUSED_PRESERVE src0_sel:BYTE_0
    s_cmp_eq_u32 s40, 1
    s_cbranch_scc0 Lg_206
    global_store_dwordx2 v13, v[16:17], s[4:5]
Lj_207:
    s_cmp_ge_u32 s24, 12
    s_cbranch_scc1 L_h1_wo
    v_mov_b32 v2, 4
    s_mov_b64 s[16:17], exec
    s_mov_b64 exec, 1
    ds_add_u32 v1, v2 offset:24
    s_mov_b64 exec, s[16:17]
    s_branch L_bulk_end
L_h1_wo:
    s_mov_b32 s19, 101
    s_mov_b32 s18, 0
Lg_208:
    global_load_dwordx4 v[48:51], v40, s[4:5] offset:0 sc1
    global_load_dwordx4 v[52:55], v41, s[4:5] offset:0 sc1
    global_load_dwordx4 v[56:59], v42, s[4:5] offset:0 sc1
    global_load_dwordx4 v[60:63], v43, s[4:5] offset:0 sc1
    s_add_u32 s18, s18, 1
    s_cmp_gt_u32 s18, 40000
    s_cbranch_scc1 L_fail
    s_waitcnt vmcnt(0)
    v_lshl_add_u64 v[48:49], v[48:49], 0, s[96:97]
    v_lshl_add_u64 v[50:51], v[50:51], 0, s[96:97]
    v_lshl_add_u64 v[52:53], v[52:53], 0, s[96:97]
    v_lshl_add_u64 v[54:55], v[54:55], 0, s[96:97]
    v_lshl_add_u64 v[56:57], v[56:57], 0, s[96:97]
    v_lshl_add_u64 v[58:59], v[58:59], 0, s[96:97]
    v_lshl_add_u64 v[60:61], v[60:61], 0, s[96:97]
    v_lshl_add_u64 v[62:63], v[62:63], 0, s[96:97]
    v_or3_b32 v2, v48, v49, v50
    v_or3_b32 v2, v2, v51, v52
    v_or3_b32 v2, v2, v53, v54
    v_or3_b32 v2, v2, v55, v56
    v_or3_b32 v2, v2, v57, v58
    v_or3_b32 v2, v2, v59, v60
    v_or3_b32 v2, v2, v61, v62
    v_or_b32 v2, v2, v63
    v_cmp_ne_u32_sdwa vcc, v2, 0 src0_sel:BYTE_0 src1_sel:DWORD
    s_cbranch_vccnz Lg_208
    v_pk_add_f32 v[48:49], v[48:49], v[52:53]
    v_pk_add_f32 v[50:51], v[50:51], v[54:55]
    v_pk_add_f32 v[48:49], v[48:49], v[56:57]
    v_pk_add_f32 v[50:51], v[50:51], v[58:59]
    v_pk_add_f32 v[48:49], v[48:49], v[60:61]
    v_pk_add_f32 v[50:51], v[50:51], v[62:63]
    v_cvt_pk_bf16_f32 v8, v48, v49
    v_cvt_pk_bf16_f32 v9, v50, v51
    ds_write_b64 v10, v[8:9] offset:1280
    s_waitcnt lgkmcnt(0)
    s_barrier
    s_branch L_bulk_end
L_h23:
    s_cmp_lg_u32 s24, 31
    s_cbranch_scc1 L_h_nowarm2
    s_cmp_lg_u32 s3, 10
    s_cbranch_scc1 L_h_nowarm2
    s_mov_b32 s19, 93
    s_mov_b32 s18, 0
    s_branch Lldsf_210
Llds_209:
    s_sleep 8
Lldsf_210:
    ds_read_b32 v2, v1 offset:40
    s_add_u32 s18, s18, 1
    s_cmp_gt_u32 s18, 400000
    s_cbranch_scc1 L_fail
    s_waitcnt lgkmcnt(0)
    v_readfirstlane_b32 s8, v2
    s_cmp_lt_u32 s8, 1
    s_cbranch_scc1 Llds_209
    s_getpc_b64 s[8:9]
Lpc_211:
    s_sub_u32 s8, s8, Lpc_211-L_code0
    s_subb_u32 s9, s9, 0
    v_lshlrev_b32 v152, 7, v0
    v_add_u32 v153, 0, v152
    v_min_u32 v153, L_exit-L_code0, v153
    v_mov_b32 v155, s9
    v_add_co_u32 v154, vcc, s8, v153
    s_nop 1
    v_addc_co_u32 v155, vcc, 0, v155, vcc
    v_add_u32 v153, 8192, v152
    v_min_u32 v153, L_exit-L_code0, v153
    v_mov_b32 v157, s9
    v_add_co_u32 v156, vcc, s8, v153
    s_nop 1
    v_addc_co_u32 v157, vcc, 0, v157, vcc
    v_add_u32 v153, 16384, v152
    v_min_u32 v153, L_exit-L_code0, v153
    v_mov_b32 v159, s9
    v_add_co_u32 v158, vcc, s8, v153
    s_nop 1
    v_addc_co_u32 v159, vcc, 0, v159, vcc
    v_add_u32 v153, 24576, v152
    v_min_u32 v153, L_exit-L_code0, v153
    v_mov_b32 v161, s9
    v_add_co_u32 v160, vcc, s8, v153
    s_nop 1
    v_addc_co_u32 v161, vcc, 0, v161, vcc
    global_load_dword v162, v[154:155], off
    global_load_dword v163, v[156:157], off
    global_load_dword v164, v[158:159], off
    global_load_dword v165, v[160:161], off
    s_waitcnt vmcnt(0)
L_h_nowarm2:
    s_sub_u32 s47, s24, 20
    s_cmp_ge_u32 s47, 10
    s_cbranch_scc1 L_bulk_end
    s_sub_u32 s27, s22, 2
    v_mov_b32 v22, 0
    v_mov_b32 v23, 0
    v_mov_b32 v44, 0
    v_mov_b32 v45, 0
    v_mov_b32 v46, 0
    v_mov_b32 v47, 0
    s_mov_b32 s19, 113
    s_mov_b32 s18, 0
    s_branch Lldsf_213
Llds_212:
    s_sleep 2
Lldsf_213:
    ds_read_b32 v2, v1 offset:16
    s_add_u32 s18, s18, 1
    s_cmp_gt_u32 s18, 400000
    s_cbranch_scc1 L_fail
    s_waitcnt lgkmcnt(0)
    v_readfirstlane_b32 s8, v2
    s_cmp_lt_u32 s8, 1
    s_cbranch_scc1 Llds_212
    s_and_b32 s40, s8, 3
    s_mov_b32 s19, 92
    s_mov_b32 s18, 0
    s_branch Lldsf_215
Llds_214:
    s_sleep 8
Lldsf_215:
    ds_read_b32 v2, v1 offset:40
    s_add_u32 s18, s18, 1
    s_cmp_gt_u32 s18, 400000
    s_cbranch_scc1 L_fail
    s_waitcnt lgkmcnt(0)
    v_readfirstlane_b32 s8, v2
    s_cmp_lt_u32 s8, 1
    s_cbranch_scc1 Llds_214
    s_load_dwordx2 s[6:7], s[0:1], 0
    s_load_dwordx2 s[48:49], s[0:1], 88
    v_bfe_u32 v2, v0, 3, 1
    v_and_b32 v3, 7, v0
    v_lshlrev_b32 v16, 8, v2
    v_lshl_add_u32 v16, v3, 4, v16
    s_add_u32 s8, s47, 20
    s_lshl_b32 s8, s8, 9
    s_lshl_b32 s9, s27, 7
    s_add_u32 s8, s8, s9
    s_add_u32 s8, s8, 8192
    v_add_u32 v16, s8, v16
    v_mul_u32_u24 v17, 1280, v2
    v_lshl_add_u32 v17, v3, 3, v17
    s_lshl_b32 s8, s47, 7
    s_lshl_b32 s9, s27, 6
    s_add_u32 s8, s8, s9
    v_add_u32 v17, s8, v17
    s_waitcnt lgkmcnt(0)
    global_load_dwordx2 v[36:37], v17, s[6:7]
    s_mov_b32 s19, 91
    s_mov_b32 s18, 0
    s_branch Lldsf_217
Llds_216:
    s_sleep 8
Lldsf_217:
    ds_read_b32 v4, v1 offset:40
    s_add_u32 s18, s18, 1
    s_cmp_gt_u32 s18, 400000
    s_cbranch_scc1 L_fail
    s_waitcnt lgkmcnt(0)
    v_readfirstlane_b32 s8, v4
    s_cmp_lt_u32 s8, 1
    s_cbranch_scc1 Llds_216
    s_mov_b32 s19, 84
    s_mov_b32 s18, 0
    s_branch Lgtf_219
Lgt_218:
    s_sleep 4
Lgtf_219:
    global_load_dwordx4 v[48:51], v16, s[4:5] sc1
    s_add_u32 s18, s18, 1
    s_cmp_gt_u32 s18, 40000
    s_cbranch_scc1 L_fail
    s_waitcnt vmcnt(0)
    v_xor_b32 v50, s20, v50
    v_xor_b32 v51, s21, v51
    v_or_b32 v4, v50, v51
    v_cmp_ne_u32 vcc, 0, v4
    s_cbranch_vccnz Lgt_218
    s_mov_b32 s12, 0xffff0000
    s_mov_b32 s13, 0xffff0000
    s_mov_b32 s10, 0
    s_mov_b32 s11, -1
    v_cndmask_b32 v2, v48, v49, s[12:13]
    v_lshlrev_b32 v24, 16, v2
    v_and_b32 v2, 0xffff0000, v2
    v_cndmask_b32 v24, v24, v2, s[10:11]
    s_mov_b32 s12, 0xffff0000
    s_mov_b32 s13, 0xffff0000
    s_mov_b32 s10, 0
    s_mov_b32 s11, -1
    v_cndmask_b32 v2, v36, v37, s[12:13]
    v_lshlrev_b32 v32, 16, v2
    v_and_b32 v2, 0xffff0000, v2
    v_cndmask_b32 v32, v32, v2, s[10:11]
    v_bfe_u32 v33, v0, 4, 1
    v_lshlrev_b32 v33, 1, v33
    v_lshrrev_b32 v2, 5, v0
    v_add_u32 v33, v33, v2
    v_lshlrev_b32 v33, 2, v33
    v_and_b32 v2, 15, v0
    v_lshl_add_u32 v33, v2, 4, v33
    v_and_b32 v2, 15, v0
    v_lshlrev_b32 v20, 4, v2
    s_lshl_b32 s8, s27, 8
    s_add_u32 s8, s8, s25
    s_add_u32 s8, s8, 4096
    v_add_u32 v20, s8, v20
    v_lshrrev_b32 v3, 5, v0
    v_mul_u32_u24 v21, 200704, v3
    v_bfe_u32 v3, v0, 4, 1
    v_mul_u32_u24 v3, 6272, v3
    v_add_u32 v21, v21, v3
    v_and_b32 v3, 3, v0
    v_lshl_add_u32 v21, v3, 4, v21
    v_bfe_u32 v3, v0, 2, 1
    v_lshl_add_u32 v21, v3, 7, v21
    v_bfe_u32 v3, v0, 3, 1
    v_lshl_add_u32 v21, v3, 6, v21
    s_mul_i32 s8, s47, 12544
    s_lshl_b32 s9, s27, 8
    s_add_u32 s8, s8, s9
    s_add_u32 s8, s8, 119296
    v_add_u32 v40, s8, v21
    s_add_u32 s8, s8, 401408
    v_add_u32 v41, s8, v21
    s_add_u32 s8, s8, 401408
    v_add_u32 v42, s8, v21
    s_add_u32 s8, s8, 401408
    v_add_u32 v43, s8, v21
    s_lshr_b32 s8, s23, 2
    s_and_b32 s9, s47, 1
    s_xor_b32 s8, s8, s9
    s_bfe_u32 s9, s23, 0x10001
    s_xor_b32 s9, s9, s27
    s_or_b32 s39, s8, s9
    s_cmp_lg_u32 s39, 0
    s_cbranch_scc1 L_h23_nored
    s_lshr_b32 s36, s47, 1
    v_bfe_u32 v2, v0, 2, 1
    v_and_b32 v3, 3, v0
    v_lshlrev_b32 v16, 8, v2
    v_lshl_add_u32 v16, v3, 4, v16
    s_lshl_b32 s8, s36, 1
    s_lshr_b32 s9, s23, 2
    s_add_u32 s8, s8, s9
    s_add_u32 s8, s8, 50
    s_lshl_b32 s8, s8, 9
    s_and_b32 s9, s23, 3
    s_lshl_b32 s9, s9, 6
    s_add_u32 s8, s8, s9
    s_add_u32 s8, s8, 8192
    v_add_u32 v16, s8, v16
    s_mov_b32 s19, 87
    s_mov_b32 s18, 0
    s_branch Lgtf_221
Lgt_220:
    s_sleep 4
Lgtf_221:
    global_load_dwordx4 v[48:51], v16, s[4:5] sc1
    s_add_u32 s18, s18, 1
    s_cmp_gt_u32 s18, 40000
    s_cbranch_scc1 L_fail
    s_waitcnt vmcnt(0)
    v_xor_b32 v50, s20, v50
    v_xor_b32 v51, s21, v51
    v_or_b32 v4, v50, v51
    v_cmp_ne_u32 vcc, 0, v4
    s_cbranch_vccnz Lgt_220
    v_mov_b32 v34, v2
    s_mov_b32 s12, 0xffff0000
    s_mov_b32 s13, 0xffff0000
    s_mov_b32 s10, 0
    s_mov_b32 s11, -1
    v_cndmask_b32 v2, v48, v49, s[12:13]
    v_lshlrev_b32 v28, 16, v2
    v_and_b32 v2, 0xffff0000, v2
    v_cndmask_b32 v28, v28, v2, s[10:11]
    v_mov_b32 v2, v34
    v_mul_u32_u24 v22, 1280, v2
    v_lshl_add_u32 v22, v3, 3, v22
    s_lshl_b32 s8, s36, 8
    s_lshl_b32 s9, s23, 5
    s_add_u32 s8, s8, s9
    v_add_u32 v22, s8, v22
    v_lshlrev_b32 v23, 7, v2
    v_lshl_add_u32 v23, v3, 4, v23
    s_and_b32 s8, s23, 1
    s_lshl_b32 s8, s8, 6
    v_add_u32 v23, s8, v23
    v_bfe_u32 v34, v0, 4, 1
    v_lshlrev_b32 v34, 1, v34
    v_lshrrev_b32 v2, 5, v0
    v_add_u32 v34, v34, v2
    v_lshlrev_b32 v34, 1, v34
    v_add_u32 v22, v22, v34
    v_lshl_add_u32 v23, v34, 1, v23
    v_lshrrev_b32 v2, 5, v0
    v_mul_u32_u24 v21, 200704, v2
    v_bfe_u32 v2, v0, 3, 2
    s_mul_i32 s8, s36, 3
    s_add_u32 s9, s36, 15
    v_add_u32 v3, s8, v2
    v_mov_b32 v4, s9
    v_cmp_eq_u32 vcc, 3, v2
    s_nop 1
    v_cndmask_b32 v2, v3, v4, vcc
    v_mul_u32_u24 v2, 6272, v2
    v_add_u32 v21, v21, v2
    v_and_b32 v2, 7, v0
    v_lshl_add_u32 v21, v2, 4, v21
    s_lshl_b32 s9, s23, 7
    s_add_u32 s8, s9, 43008
    v_add_u32 v44, s8, v21
    s_add_u32 s8, s8, 401408
    v_add_u32 v45, s8, v21
    s_add_u32 s8, s8, 401408
    v_add_u32 v46, s8, v21
    s_add_u32 s8, s8, 401408
    v_add_u32 v47, s8, v21
L_h23_nored:
    s_barrier
    s_barrier
    v_mov_b32 v4, s20
    v_mov_b32 v5, s21
    s_mov_b32 s19, 122
    s_mov_b32 s18, 0
    s_branch Lldsf_223
Llds_222:
    s_sleep 1
Lldsf_223:
    ds_read_b32 v2, v1 offset:24
    s_add_u32 s18, s18, 1
    s_cmp_gt_u32 s18, 400000
    s_cbranch_scc1 L_fail
    s_waitcnt lgkmcnt(0)
    v_readfirstlane_b32 s8, v2
    s_cmp_lt_u32 s8, 4
    s_cbranch_scc1 Llds_222
    s_sleep 10
    s_mov_b32 s19, 99
    s_mov_b32 s18, 0
    global_load_dwordx4 v[64:67], v40, s[4:5] sc1
    global_load_dwordx4 v[68:71], v41, s[4:5] sc1
    global_load_dwordx4 v[72:75], v42, s[4:5] sc1
    global_load_dwordx4 v[76:79], v43, s[4:5] sc1
    s_sleep 8
    global_load_dwordx4 v[80:83], v40, s[4:5] offset:2560 sc1
    global_load_dwordx4 v[84:87], v41, s[4:5] offset:2560 sc1
    global_load_dwordx4 v[88:91], v42, s[4:5] offset:2560 sc1
    global_load_dwordx4 v[92:95], v43, s[4:5] offset:2560 sc1
Lpp_224:
    s_waitcnt vmcnt(4)
    v_lshl_add_u64 v[64:65], v[64:65], 0, s[96:97]
    v_lshl_add_u64 v[66:67], v[66:67], 0, s[96:97]
    v_lshl_add_u64 v[68:69], v[68:69], 0, s[96:97]
    v_lshl_add_u64 v[70:71], v[70:71], 0, s[96:97]
    v_lshl_add_u64 v[72:73], v[72:73], 0, s[96:97]
    v_lshl_add_u64 v[74:75], v[74:75], 0, s[96:97]
    v_lshl_add_u64 v[76:77], v[76:77], 0, s[96:97]
    v_lshl_add_u64 v[78:79], v[78:79], 0, s[96:97]
    v_or3_b32 v2, v64, v65, v66
    v_or3_b32 v2, v2, v67, v68
    v_or3_b32 v2, v2, v69, v70
    v_or3_b32 v2, v2, v71, v72
    v_or3_b32 v2, v2, v73, v74
    v_or3_b32 v2, v2, v75, v76
    v_or3_b32 v2, v2, v77, v78
    v_or_b32 v2, v2, v79
    v_cmp_ne_u32_sdwa vcc, v2, 0 src0_sel:BYTE_0 src1_sel:DWORD
    s_cbranch_vccz Lppok_225_0
    global_load_dwordx4 v[64:67], v40, s[4:5] sc1
    global_load_dwordx4 v[68:71], v41, s[4:5] sc1
    global_load_dwordx4 v[72:75], v42, s[4:5] sc1
    global_load_dwordx4 v[76:79], v43, s[4:5] sc1
    s_sleep 4
    s_waitcnt vmcnt(4)
    v_lshl_add_u64 v[80:81], v[80:81], 0, s[96:97]
    v_lshl_add_u64 v[82:83], v[82:83], 0, s[96:97]
    v_lshl_add_u64 v[84:85], v[84:85], 0, s[96:97]
    v_lshl_add_u64 v[86:87], v[86:87], 0, s[96:97]
    v_lshl_add_u64 v[88:89], v[88:89], 0, s[96:97]
    v_lshl_add_u64 v[90:91], v[90:91], 0, s[96:97]
    v_lshl_add_u64 v[92:93], v[92:93], 0, s[96:97]
    v_lshl_add_u64 v[94:95], v[94:95], 0, s[96:97]
    v_or3_b32 v2, v80, v81, v82
    v_or3_b32 v2, v2, v83, v84
    v_or3_b32 v2, v2, v85, v86
    v_or3_b32 v2, v2, v87, v88
    v_or3_b32 v2, v2, v89, v90
    v_or3_b32 v2, v2, v91, v92
    v_or3_b32 v2, v2, v93, v94
    v_or_b32 v2, v2, v95
    v_cmp_ne_u32_sdwa vcc, v2, 0 src0_sel:BYTE_0 src1_sel:DWORD
    s_cbranch_vccz Lppok_225_1
    global_load_dwordx4 v[80:83], v40, s[4:5] offset:2560 sc1
    global_load_dwordx4 v[84:87], v41, s[4:5] offset:2560 sc1
    global_load_dwordx4 v[88:91], v42, s[4:5] offset:2560 sc1
    global_load_dwordx4 v[92:95], v43, s[4:5] offset:2560 sc1
    s_sleep 4
    s_add_u32 s18, s18, 1
    s_cmp_gt_u32 s18, 40000
    s_cbranch_scc1 L_fail
    s_branch Lpp_224
Lppok_225_1:
    v_pk_add_f32 v[48:49], v[80:81], v[84:85]
    v_pk_add_f32 v[50:51], v[82:83], v[86:87]
    v_pk_add_f32 v[48:49], v[48:49], v[88:89]
    v_pk_add_f32 v[50:51], v[50:51], v[90:91]
    v_pk_add_f32 v[48:49], v[48:49], v[92:93]
    v_pk_add_f32 v[50:51], v[50:51], v[94:95]
    s_branch Lppok_225
Lppok_225_0:
    v_pk_add_f32 v[48:49], v[64:65], v[68:69]
    v_pk_add_f32 v[50:51], v[66:67], v[70:71]
    v_pk_add_f32 v[48:49], v[48:49], v[72:73]
    v_pk_add_f32 v[50:51], v[50:51], v[74:75]
    v_pk_add_f32 v[48:49], v[48:49], v[76:77]
    v_pk_add_f32 v[50:51], v[50:51], v[78:79]
Lppok_225:
    s_nop 0
    v_permlane32_swap_b32 v48, v49
    v_permlane32_swap_b32 v50, v51
    v_add_f32 v48, v48, v49
    v_add_f32 v50, v50, v51
    s_nop 1
    v_permlane16_swap_b32 v48, v50
    v_add_f32 v48, v48, v50
    v_cvt_pk_bf16_f32 v48, 0, v48
    v_mul_f32 v48, v48, v24
    v_cvt_pk_bf16_f32 v48, 0, v48
    v_add_f32 v48, v32, v48
    v_mov_b32 v49, v48
    v_cvt_pk_bf16_f32 v32, 0, v48
    s_nop 0
    v_permlane32_swap_b32 v48, v49
    v_cvt_pk_bf16_f32 v2, v48, v49
    v_mov_b32 v3, v2
    s_nop 1
    v_permlane16_swap_b32 v2, v3
    s_mov_b64 exec, 0xffff
    s_cmp_eq_u32 s40, 1
    s_cbranch_scc0 Lg_226
    global_store_dwordx4 v20, v[2:5], s[4:5]
Lj_227:
    s_mov_b64 exec, -1
    s_waitcnt vmcnt(0)
    v_mov_b32 v4, 1
    s_mov_b64 s[16:17], exec
    s_mov_b64 exec, 1
    ds_add_u32 v1, v4 offset:144
    s_mov_b64 exec, s[16:17]
    s_cmp_lg_u32 s39, 0
    s_cbranch_scc1 L_h23_nofin
    ds_write_b32 v33, v32 offset:768
    s_waitcnt lgkmcnt(0)
    ds_read_b32 v32, v23 offset:768
    s_mov_b32 s19, 123
    s_mov_b32 s18, 0
    s_branch Lldsf_229
Llds_228:
    s_sleep 1
Lldsf_229:
    ds_read_b32 v2, v1 offset:144
    s_add_u32 s18, s18, 1
    s_cmp_gt_u32 s18, 400000
    s_cbranch_scc1 L_fail
    s_waitcnt lgkmcnt(0)
    v_readfirstlane_b32 s8, v2
    s_cmp_lt_u32 s8, 2
    s_cbranch_scc1 Llds_228
    v_mov_b32 v68, s98
    v_mov_b32 v69, s98
    v_mov_b32 v70, s98
    v_mov_b32 v71, s98
    v_mov_b32 v72, s98
    v_mov_b32 v73, s98
    v_mov_b32 v74, s98
    v_mov_b32 v75, s98
    v_mov_b32 v76, s98
    v_mov_b32 v77, s98
    v_mov_b32 v78, s98
    v_mov_b32 v79, s98
    v_mov_b32 v84, s98
    v_mov_b32 v85, s98
    v_mov_b32 v86, s98
    v_mov_b32 v87, s98
    v_mov_b32 v88, s98
    v_mov_b32 v89, s98
    v_mov_b32 v90, s98
    v_mov_b32 v91, s98
    v_mov_b32 v92, s98
    v_mov_b32 v93, s98
    v_mov_b32 v94, s98
    v_mov_b32 v95, s98
    s_mov_b32 s19, 100
    s_mov_b32 s18, 0
    global_load_dwordx4 v[64:67], v44, s[4:5] sc1
    s_mov_b64 s[16:17], exec
    s_mov_b32 exec_lo, 4294967295
    s_mov_b32 exec_hi, 16777215
    global_load_dwordx4 v[68:71], v45, s[4:5] sc1
    s_mov_b64 exec, s[16:17]
    s_mov_b64 s[16:17], exec
    s_mov_b32 exec_lo, 16777215
    s_mov_b32 exec_hi, 16777215
    global_load_dwordx4 v[72:75], v46, s[4:5] sc1
    s_mov_b64 exec, s[16:17]
    s_mov_b64 s[16:17], exec
    s_mov_b32 exec_lo, 16777215
    s_mov_b32 exec_hi, 16777215
    global_load_dwordx4 v[76:79], v47, s[4:5] sc1
    s_mov_b64 exec, s[16:17]
    s_sleep 6
    global_load_dwordx4 v[80:83], v44, s[4:5] offset:2560 sc1
    s_mov_b64 s[16:17], exec
    s_mov_b32 exec_lo, 4294967295
    s_mov_b32 exec_hi, 16777215
    global_load_dwordx4 v[84:87], v45, s[4:5] offset:2560 sc1
    s_mov_b64 exec, s[16:17]
    s_mov_b64 s[16:17], exec
    s_mov_b32 exec_lo, 16777215
    s_mov_b32 exec_hi, 16777215
    global_load_dwordx4 v[88:91], v46, s[4:5] offset:2560 sc1
    s_mov_b64 exec, s[16:17]
    s_mov_b64 s[16:17], exec
    s_mov_b32 exec_lo, 16777215
    s_mov_b32 exec_hi, 16777215
    global_load_dwordx4 v[92:95], v47, s[4:5] offset:2560 sc1
    s_mov_b64 exec, s[16:17]
Lpp_230:
    s_waitcnt vmcnt(4)
    v_lshl_add_u64 v[96:97], v[64:65], 0, s[96:97]
    v_lshl_add_u64 v[98:99], v[66:67], 0, s[96:97]
    v_lshl_add_u64 v[100:101], v[68:69], 0, s[96:97]
    v_lshl_add_u64 v[102:103], v[70:71], 0, s[96:97]
    v_lshl_add_u64 v[104:105], v[72:73], 0, s[96:97]
    v_lshl_add_u64 v[106:107], v[74:75], 0, s[96:97]
    v_lshl_add_u64 v[108:109], v[76:77], 0, s[96:97]
    v_lshl_add_u64 v[110:111], v[78:79], 0, s[96:97]
    v_or3_b32 v2, v96, v97, v98
    v_or3_b32 v2, v2, v99, v100
    v_or3_b32 v2, v2, v101, v102
    v_or3_b32 v2, v2, v103, v104
    v_or3_b32 v2, v2, v105, v106
    v_or3_b32 v2, v2, v107, v108
    v_or3_b32 v2, v2, v109, v110
    v_or_b32 v2, v2, v111
    v_cmp_ne_u32_sdwa vcc, v2, 0 src0_sel:BYTE_0 src1_sel:DWORD
    s_cbranch_vccz Lppok_231_0
    global_load_dwordx4 v[64:67], v44, s[4:5] sc1
    s_mov_b64 s[16:17], exec
    s_mov_b32 exec_lo, 4294967295
    s_mov_b32 exec_hi, 16777215
    global_load_dwordx4 v[68:71], v45, s[4:5] sc1
    s_mov_b64 exec, s[16:17]
    s_mov_b64 s[16:17], exec
    s_mov_b32 exec_lo, 16777215
    s_mov_b32 exec_hi, 16777215
    global_load_dwordx4 v[72:75], v46, s[4:5] sc1
    s_mov_b64 exec, s[16:17]
    s_mov_b64 s[16:17], exec
    s_mov_b32 exec_lo, 16777215
    s_mov_b32 exec_hi, 16777215
    global_load_dwordx4 v[76:79], v47, s[4:5] sc1
    s_mov_b64 exec, s[16:17]
    s_sleep 3
    s_waitcnt vmcnt(4)
    v_lshl_add_u64 v[96:97], v[80:81], 0, s[96:97]
    v_lshl_add_u64 v[98:99], v[82:83], 0, s[96:97]
    v_lshl_add_u64 v[100:101], v[84:85], 0, s[96:97]
    v_lshl_add_u64 v[102:103], v[86:87], 0, s[96:97]
    v_lshl_add_u64 v[104:105], v[88:89], 0, s[96:97]
    v_lshl_add_u64 v[106:107], v[90:91], 0, s[96:97]
    v_lshl_add_u64 v[108:109], v[92:93], 0, s[96:97]
    v_lshl_add_u64 v[110:111], v[94:95], 0, s[96:97]
    v_or3_b32 v2, v96, v97, v98
    v_or3_b32 v2, v2, v99, v100
    v_or3_b32 v2, v2, v101, v102
    v_or3_b32 v2, v2, v103, v104
    v_or3_b32 v2, v2, v105, v106
    v_or3_b32 v2, v2, v107, v108
    v_or3_b32 v2, v2, v109, v110
    v_or_b32 v2, v2, v111
    v_cmp_ne_u32_sdwa vcc, v2, 0 src0_sel:BYTE_0 src1_sel:DWORD
    s_cbranch_vccz Lppok_231_1
    global_load_dwordx4 v[80:83], v44, s[4:5] offset:2560 sc1
    s_mov_b64 s[16:17], exec
    s_mov_b32 exec_lo, 4294967295
    s_mov_b32 exec_hi, 16777215
    global_load_dwordx4 v[84:87], v45, s[4:5] offset:2560 sc1
    s_mov_b64 exec, s[16:17]
    s_mov_b64 s[16:17], exec
    s_mov_b32 exec_lo, 16777215
    s_mov_b32 exec_hi, 16777215
    global_load_dwordx4 v[88:91], v46, s[4:5] offset:2560 sc1
    s_mov_b64 exec, s[16:17]
    s_mov_b64 s[16:17], exec
    s_mov_b32 exec_lo, 16777215
    s_mov_b32 exec_hi, 16777215
    global_load_dwordx4 v[92:95], v47, s[4:5] offset:2560 sc1
    s_mov_b64 exec, s[16:17]
    s_sleep 3
    s_add_u32 s18, s18, 1
    s_cmp_gt_u32 s18, 40000
    s_cbranch_scc1 L_fail
    s_branch Lpp_230
Lppok_231_1:
    v_pk_add_f32 v[48:49], v[96:97], v[100:101]
    v_pk_add_f32 v[50:51], v[98:99], v[102:103]
    v_pk_add_f32 v[48:49], v[48:49], v[104:105]
    v_pk_add_f32 v[50:51], v[50:51], v[106:107]
    v_pk_add_f32 v[48:49], v[48:49], v[108:109]
    v_pk_add_f32 v[50:51], v[50:51], v[110:111]
    s_branch Lppok_231
Lppok_231_0:
    v_pk_add_f32 v[48:49], v[96:97], v[100:101]
    v_pk_add_f32 v[50:51], v[98:99], v[102:103]
    v_pk_add_f32 v[48:49], v[48:49], v[104:105]
    v_pk_add_f32 v[50:51], v[50:51], v[106:107]
    v_pk_add_f32 v[48:49], v[48:49], v[108:109]
    v_pk_add_f32 v[50:51], v[50:51], v[110:111]
Lppok_231:
    s_nop 0
    v_permlane32_swap_b32 v48, v49
    v_permlane32_swap_b32 v50, v51
    v_add_f32 v48, v48, v49
    v_add_f32 v50, v50, v51
    s_nop 1
    v_permlane16_swap_b32 v48, v50
    v_add_f32 v48, v48, v50
    s_nop 1
    v_add_f32_dpp v48, v48, v48 row_ror:8 row_mask:0xf bank_mask:0xf
    s_waitcnt lgkmcnt(0)
    v_cvt_pk_bf16_f32 v48, 0, v48
    v_mul_f32 v48, v48, v28
    v_cvt_pk_bf16_f32 v48, 0, v48
    v_add_f32 v48, v32, v48
    v_cvt_pk_bf16_f32 v2, v48, v48
    s_mov_b32 exec_lo, 0x00ff00ff
    s_mov_b32 exec_hi, 0x00ff00ff
    global_store_short v22, v2, s[48:49]
    s_mov_b64 exec, -1
    s_branch L_bulk_end
L_h23_nofin:
    s_or_b32 s8, s23, s47
    s_xor_b32 s9, s27, 1
    s_or_b32 s8, s8, s9
    s_cmp_lg_u32 s8, 0
    s_cbranch_scc1 L_bulk_end
    v_mov_b32 v2, s20
    s_mov_b64 exec, 1
    global_store_dword v1, v2, s[4:5] sc1
L_bulk_end:
    s_endpgm
L_h0_mode:
    s_mov_b32 s19, 95
    s_mov_b32 s18, 0
    s_branch Lldsf_233
Llds_232:
    s_sleep 8
Lldsf_233:
    ds_read_b32 v2, v1 offset:44
    s_add_u32 s18, s18, 1
    s_cmp_gt_u32 s18, 400000
    s_cbranch_scc1 L_fail
    s_waitcnt lgkmcnt(0)
    v_readfirstlane_b32 s8, v2
    s_cmp_lt_u32 s8, 1
    s_cbranch_scc1 Llds_232
    v_and_b32 v2, 31, v0
    v_lshlrev_b32 v2, 3, v2
    s_lshl_b32 s8, s23, 8
    s_add_u32 s8, s8, 4096
    v_add_u32 v2, s8, v2
    s_mov_b32 s19, 0x50
    s_mov_b32 s18, 0
    s_branch Lgmf_235
Lgm_234:
    s_sleep 1
Lgmf_235:
    global_load_dwordx2 v[40:41], v2, s[4:5] sc1
    s_add_u32 s18, s18, 1
    s_cmp_gt_u32 s18, 40000
    s_cbranch_scc1 L_fail
    s_waitcnt vmcnt(0)
    v_xor_b32 v40, s20, v40
    v_xor_b32 v41, s21, v41
    v_lshrrev_b32 v3, 4, v41
    v_or_b32 v3, v40, v3
    v_cmp_ne_u32 vcc, 0, v3
    s_cbranch_vccnz Lgm_234
    v_cmp_ne_u32 vcc, s41, v41
    s_cmp_eq_u64 vcc, 0
    s_cselect_b32 s40, 1, 2
    s_lshl_b32 s8, s98, 8
    s_or_b32 s8, s8, s40
    v_mov_b32 v3, s8
    ds_write_b32 v1, v3 offset:16
    s_waitcnt lgkmcnt(0)
L_h0_main:
    s_mov_b32 s19, 88
    s_mov_b32 s18, 0
Llds_236:
    ds_read_b32 v2, v1 offset:16
    s_add_u32 s18, s18, 1
    s_cmp_gt_u32 s18, 400000
    s_cbranch_scc1 L_fail
    s_waitcnt lgkmcnt(0)
    v_readfirstlane_b32 s8, v2
    s_cmp_lt_u32 s8, 1
    s_cbranch_scc1 Llds_236
    s_and_b32 s40, s8, 3
    s_bfe_u32 s8, s24, 0x20001
    s_add_u32 s8, s8, 8
    s_mul_i32 s9, s8, 6272
    s_add_u32 s9, s9, s42
    s_and_b32 s8, s24, 1
    s_lshl_b32 s8, s8, 9
    s_add_u32 s9, s9, s8
    s_add_u32 s9, s9, 0
    v_and_b32 v2, 31, v0
    v_lshlrev_b32 v2, 4, v2
    v_add_u32 v16, s9, v2
    s_add_u32 s9, s9, 25088
    v_add_u32 v17, s9, v2
    s_add_u32 s9, s9, 25088
    v_add_u32 v18, s9, v2
    s_add_u32 s9, s9, 25088
    v_add_u32 v19, s9, v2
    s_add_u32 s9, s9, 25088
    v_add_u32 v20, s9, v2
    s_mov_b32 s19, 89
    s_mov_b32 s18, 0
    s_branch Lldsf_238
Llds_237:
    s_sleep 4
Lldsf_238:
    ds_read_b32 v3, v1 offset:36
    s_add_u32 s18, s18, 1
    s_cmp_gt_u32 s18, 400000
    s_cbranch_scc1 L_fail
    s_waitcnt lgkmcnt(0)
    v_readfirstlane_b32 s8, v3
    s_cmp_lt_u32 s8, 1
    s_cbranch_scc1 Llds_237
    s_mov_b32 exec_hi, 0
    s_mov_b32 s19, 81
    s_mov_b32 s18, 0
    s_branch Lgf_240
Lg_239:
    s_sleep 8
Lgf_240:
    global_load_dwordx4 v[48:51], v16, s[4:5] offset:0 sc1
    global_load_dwordx4 v[52:55], v17, s[4:5] offset:0 sc1
    global_load_dwordx4 v[56:59], v18, s[4:5] offset:0 sc1
    global_load_dwordx4 v[60:63], v19, s[4:5] offset:0 sc1
    global_load_dwordx4 v[64:67], v20, s[4:5] offset:0 sc1
    s_add_u32 s18, s18, 1
    s_cmp_gt_u32 s18, 40000
    s_cbranch_scc1 L_fail
    s_waitcnt vmcnt(0)
    v_lshl_add_u64 v[48:49], v[48:49], 0, s[96:97]
    v_lshl_add_u64 v[50:51], v[50:51], 0, s[96:97]
    v_lshl_add_u64 v[52:53], v[52:53], 0, s[96:97]
    v_lshl_add_u64 v[54:55], v[54:55], 0, s[96:97]
    v_lshl_add_u64 v[56:57], v[56:57], 0, s[96:97]
    v_lshl_add_u64 v[58:59], v[58:59], 0, s[96:97]
    v_lshl_add_u64 v[60:61], v[60:61], 0, s[96:97]
    v_lshl_add_u64 v[62:63], v[62:63], 0, s[96:97]
    v_lshl_add_u64 v[64:65], v[64:65], 0, s[96:97]
    v_lshl_add_u64 v[66:67], v[66:67], 0, s[96:97]
    v_or3_b32 v3, v48, v49, v50
    v_or3_b32 v3, v3, v51, v52
    v_or3_b32 v3, v3, v53, v54
    v_or3_b32 v3, v3, v55, v56
    v_or3_b32 v3, v3, v57, v58
    v_or3_b32 v3, v3, v59, v60
    v_or3_b32 v3, v3, v61, v62
    v_or3_b32 v3, v3, v63, v64
    v_or3_b32 v3, v3, v65, v66
    v_or_b32 v3, v3, v67
    v_cmp_ne_u32_sdwa vcc, v3, 0 src0_sel:BYTE_0 src1_sel:DWORD
    s_cbranch_vccnz Lg_239
    v_pk_add_f32 v[48:49], v[48:49], v[52:53]
    v_pk_add_f32 v[50:51], v[50:51], v[54:55]
    v_pk_add_f32 v[48:49], v[48:49], v[56:57]
    v_pk_add_f32 v[50:51], v[50:51], v[58:59]
    v_pk_add_f32 v[48:49], v[48:49], v[60:61]
    v_pk_add_f32 v[50:51], v[50:51], v[62:63]
    v_pk_add_f32 v[48:49], v[48:49], v[64:65]
    v_pk_add_f32 v[50:51], v[50:51], v[66:67]
    v_cvt_pk_bf16_f32 v8, v48, v49
    v_cvt_pk_bf16_f32 v9, v50, v51
    v_lshrrev_b32 v2, 1, v2
    ds_write_b64 v2, v[8:9] offset:256
    s_waitcnt lgkmcnt(0)
    s_mov_b64 exec, -1
    v_mov_b32 v2, 1
    s_mov_b64 s[16:17], exec
    s_mov_b64 exec, 1
    ds_add_u32 v1, v2 offset:12
    s_mov_b64 exec, s[16:17]
    v_and_b32 v2, 7, v0
    v_lshlrev_b32 v2, 3, v2
    s_mov_b32 s19, 0x52
    s_mov_b32 s18, 0
Lml_241:
    s_sleep 1
    ds_read_b64 v[8:9], v2 offset:64
    s_add_u32 s18, s18, 1
    s_cmp_gt_u32 s18, 400000
    s_cbranch_scc1 L_fail
    s_waitcnt lgkmcnt(0)
    v_max_u32 v10, v8, v9
    v_cmp_eq_u32 vcc, -1, v10
    s_cbranch_vccnz Lml_241
    v_mov_b32 v10, v8
    s_nop 1
    v_max_f32_dpp v10, v10, v10 quad_perm:[1,0,3,2] row_mask:0xf bank_mask:0xf
    s_nop 1
    v_max_f32_dpp v10, v10, v10 quad_perm:[2,3,0,1] row_mask:0xf bank_mask:0xf
    s_nop 1
    v_max_f32_dpp v10, v10, v10 row_half_mirror row_mask:0xf bank_mask:0xf
    v_sub_f32 v8, v8, v10
    v_mul_f32 v8, 0x3fb8aa3b, v8
    v_exp_f32 v8, v8
    s_nop 0
    v_mul_f32 v11, v8, v9
    s_nop 1
    v_add_f32_dpp v11, v11, v11 quad_perm:[1,0,3,2] row_mask:0xf bank_mask:0xf
    s_nop 1
    v_add_f32_dpp v11, v11, v11 quad_perm:[2,3,0,1] row_mask:0xf bank_mask:0xf
    s_nop 1
    v_add_f32_dpp v11, v11, v11 row_half_mirror row_mask:0xf bank_mask:0xf
    s_add_u32 s8, s25, 6144
    v_mov_b32 v2, s8
    s_mov_b64 exec, 1
    v_mov_b32 v12, s20
    v_mov_b32 v13, s21
    s_cmp_eq_u32 s40, 1
    s_cbranch_scc0 Lg_242
    global_store_dwordx4 v2, v[10:13], s[4:5]
Lj_243:
    s_mov_b64 exec, -1
    s_and_b32 s8, s24, 7
    s_lshr_b32 s9, s24, 3
    s_cmp_lt_u32 s8, 4
    s_cselect_b32 s10, 1, 3
    s_cmp_eq_u32 s9, s10
    s_cselect_b32 s52, 2, 0
    s_cmp_eq_u32 s9, 0
    s_cselect_b32 s52, 1, s52
    s_cmp_ge_u32 s23, 4
    s_cselect_b32 s10, 7, 8
    s_cmp_eq_u32 s8, s10
    s_cselect_b32 s52, 0, s52
    s_cmp_lg_u32 s52, 1
    s_cbranch_scc1 Ldon_244
    v_lshlrev_b32 v2, 4, v0
    s_add_u32 s8, s25, 3072
    v_add_u32 v3, s8, v2
    s_mov_b32 exec_hi, 0
    ds_read_b128 v[48:51], v2 offset:4096
    s_waitcnt lgkmcnt(0)
    v_mov_b32_sdwa v48, s20 dst_sel:BYTE_0 dst_unused:UNUSED_PRESERVE src0_sel:BYTE_0
    v_mov_b32_sdwa v49, s20 dst_sel:BYTE_0 dst_unused:UNUSED_PRESERVE src0_sel:BYTE_0
    v_mov_b32_sdwa v50, s20 dst_sel:BYTE_0 dst_unused:UNUSED_PRESERVE src0_sel:BYTE_0
    v_mov_b32_sdwa v51, s20 dst_sel:BYTE_0 dst_unused:UNUSED_PRESERVE src0_sel:BYTE_0
    s_cmp_eq_u32 s40, 1
    s_cbranch_scc0 Lg_245
    global_store_dwordx4 v3, v[48:51], s[4:5]
Lj_246:
    s_mov_b64 exec, -1
Ldon_244:
    s_and_b32 s8, s24, 7
    v_and_b32 v2, 3, v0
    v_lshlrev_b32 v2, 3, v2
    v_add_u32 v2, s8, v2
    v_mul_u32_u24 v2, 6272, v2
    s_add_u32 s8, s42, 6144
    v_add_u32 v16, s8, v2
    s_mov_b64 exec, 15
    s_mov_b32 s19, 83
    s_mov_b32 s18, 0
    s_branch Lgf_248
Lg_247:
    s_sleep 8
Lgf_248:
    global_load_dwordx4 v[8:11], v16, s[4:5] offset:0 sc1
    s_add_u32 s18, s18, 1
    s_cmp_gt_u32 s18, 40000
    s_cbranch_scc1 L_fail
    s_waitcnt vmcnt(0)
    v_xor_b32 v3, s20, v10
    v_cmp_ne_u32 vcc, 0, v3
    s_cbranch_vccnz Lg_247
    s_mov_b64 exec, -1
    v_mov_b32 v10, v8
    s_nop 1
    v_max_f32_dpp v10, v10, v10 quad_perm:[1,0,3,2] row_mask:0xf bank_mask:0xf
    s_nop 1
    v_max_f32_dpp v10, v10, v10 quad_perm:[2,3,0,1] row_mask:0xf bank_mask:0xf
    v_sub_f32 v8, v8, v10
    v_mul_f32 v8, 0x3fb8aa3b, v8
    v_exp_f32 v8, v8
    s_nop 0
    v_mul_f32 v11, v8, v9
    s_nop 1
    v_add_f32_dpp v11, v11, v11 quad_perm:[1,0,3,2] row_mask:0xf bank_mask:0xf
    s_nop 1
    v_add_f32_dpp v11, v11, v11 quad_perm:[2,3,0,1] row_mask:0xf bank_mask:0xf
    v_rcp_f32 v11, v11
    s_mov_b64 exec, 1
    ds_write_b64 v1, v[10:11] offset:128
    s_mov_b64 exec, -1
    s_cmp_lg_u32 s52, 2
    s_cbranch_scc1 Ldt_249
    v_readfirstlane_b32 s12, v10
    v_readfirstlane_b32 s13, v11
    s_and_b32 s8, s24, 7
    s_mul_i32 s8, s8, 6272
    s_add_u32 s8, s8, s42
    s_add_u32 s8, s8, 3072
    v_lshlrev_b32 v20, 4, v0
    v_add_u32 v16, s8, v20
    v_add_u32 v20, 122880, v20
    s_mov_b32 exec_hi, 0
    s_mov_b32 s19, 94
    s_mov_b32 s18, 0
    s_branch Lgf_251
Lg_250:
    s_sleep 4
Lgf_251:
    global_load_dwordx4 v[48:51], v16, s[4:5] offset:0 sc1
    s_add_u32 s18, s18, 1
    s_cmp_gt_u32 s18, 40000
    s_cbranch_scc1 L_fail
    s_waitcnt vmcnt(0)
    v_lshl_add_u64 v[48:49], v[48:49], 0, s[96:97]
    v_lshl_add_u64 v[50:51], v[50:51], 0, s[96:97]
    v_or3_b32 v2, v48, v49, v50
    v_or_b32 v2, v2, v51
    v_cmp_ne_u32_sdwa vcc, v2, 0 src0_sel:BYTE_0 src1_sel:DWORD
    s_cbranch_vccnz Lg_250
    v_subrev_f32 v48, s12, v48
    v_subrev_f32 v49, s12, v49
    v_subrev_f32 v50, s12, v50
    v_subrev_f32 v51, s12, v51
    v_mul_f32 v48, 0x3fb8aa3b, v48
    v_mul_f32 v49, 0x3fb8aa3b, v49
    v_mul_f32 v50, 0x3fb8aa3b, v50
    v_mul_f32 v51, 0x3fb8aa3b, v51
    v_exp_f32 v48, v48
    v_exp_f32 v49, v49
    v_exp_f32 v50, v50
    v_exp_f32 v51, v51
    v_mul_f32 v48, s13, v48
    v_mul_f32 v49, s13, v49
    v_mul_f32 v50, s13, v50
    v_mul_f32 v51, s13, v51
    v_cvt_pk_bf16_f32 v48, v48, v48
    v_cvt_pk_bf16_f32 v49, v49, v49
    v_cvt_pk_bf16_f32 v50, v50, v50
    v_cvt_pk_bf16_f32 v51, v51, v51
    ds_write_b128 v20, v[48:51]
    s_waitcnt lgkmcnt(0)
    s_mov_b64 exec, -1
    v_mov_b32 v2, 1
    s_mov_b64 s[16:17], exec
    s_mov_b64 exec, 1
    ds_add_u32 v1, v2 offset:52
    s_mov_b64 exec, s[16:17]
Ldt_249:
    s_mul_i32 s34, s24, 43
    s_lshr_b32 s34, s34, 7
    s_mul_i32 s8, s34, 3
    s_sub_u32 s35, s24, s8
    s_sub_u32 s8, s24, 15
    s_cmp_ge_u32 s24, 15
    s_cselect_b32 s34, s8, s34
    s_cselect_b32 s35, 3, s35
    s_min_u32 s9, s23, 3
    s_mul_i32 s36, s23, 3
    s_add_u32 s36, s36, s9
    s_add_u32 s36, s36, s35
    s_cmp_lt_u32 s23, 3
    s_cselect_b32 s8, 20, 15
    s_cmp_lt_u32 s24, s8
    s_cselect_b32 s43, 1, 0
    s_cmp_eq_u32 s43, 0
    s_cbranch_scc1 L_h0_roles
    v_bfe_u32 v2, v0, 4, 1
    v_lshlrev_b32 v16, 9, v2
    v_lshrrev_b32 v2, 5, v0
    v_lshl_add_u32 v16, v2, 8, v16
    v_and_b32 v2, 15, v0
    v_lshl_add_u32 v16, v2, 4, v16
    s_lshl_b32 s8, s34, 10
    s_add_u32 s8, s8, 23552
    v_add_u32 v16, s8, v16
    v_add_u32 v17, 5120, v16
    s_mov_b32 s19, 85
    s_mov_b32 s18, 0
    s_branch Lgtf_253
Lgt_252:
    s_sleep 4
Lgtf_253:
    global_load_dwordx4 v[48:51], v16, s[4:5] sc1
    global_load_dwordx4 v[52:55], v17, s[4:5] sc1
    s_add_u32 s18, s18, 1
    s_cmp_gt_u32 s18, 40000
    s_cbranch_scc1 L_fail
    s_waitcnt vmcnt(0)
    v_xor_b32 v50, s20, v50
    v_xor_b32 v51, s21, v51
    v_or_b32 v2, v50, v51
    v_xor_b32 v54, s20, v54
    v_xor_b32 v55, s21, v55
    v_or3_b32 v2, v2, v54, v55
    v_cmp_ne_u32 vcc, 0, v2
    s_cbranch_vccnz Lgt_252
    v_lshlrev_b32 v28, 16, v48
    v_and_b32 v29, 0xffff0000, v48
    v_lshlrev_b32 v30, 16, v49
    v_and_b32 v31, 0xffff0000, v49
    v_lshlrev_b32 v24, 16, v52
    v_and_b32 v25, 0xffff0000, v52
    v_lshlrev_b32 v26, 16, v53
    v_and_b32 v27, 0xffff0000, v53
    v_add_f32 v24, 1.0, v24
    v_add_f32 v25, 1.0, v25
    v_add_f32 v26, 1.0, v26
    v_add_f32 v27, 1.0, v27
    v_cvt_pk_bf16_f32 v2, v24, v25
    v_cvt_pk_bf16_f32 v3, v26, v27
    v_lshlrev_b32 v24, 16, v2
    v_and_b32 v25, 0xffff0000, v2
    v_lshlrev_b32 v26, 16, v3
    v_and_b32 v27, 0xffff0000, v3
L_h0_roles:
    s_and_b32 s8, s24, 1
    s_lshl_b32 s8, s8, 1
    s_add_u32 s8, s8, 0
    s_mul_i32 s8, s8, 12544
    s_add_u32 s8, s8, s42
    s_add_u32 s8, s8, 3584
    v_lshrrev_b32 v2, 5, v0
    v_mul_u32_u24 v3, 6272, v2
    v_and_b32 v4, 31, v0
    v_lshl_add_u32 v3, v4, 4, v3
    v_add_u32 v40, s8, v3
    s_add_u32 s8, s8, 50176
    v_add_u32 v41, s8, v3
    s_add_u32 s8, s8, 50176
    v_add_u32 v42, s8, v3
    s_add_u32 s8, s8, 50176
    v_add_u32 v43, s8, v3
    v_lshlrev_b32 v10, 9, v2
    v_lshl_add_u32 v10, v4, 3, v10
    s_cmp_eq_u32 s43, 0
    s_cbranch_scc1 L_h0_nod
    v_bfe_u32 v2, v0, 4, 1
    v_mul_u32_u24 v2, 6272, v2
    v_bfe_u32 v3, v0, 3, 1
    v_lshl_add_u32 v2, v3, 8, v2
    v_lshrrev_b32 v3, 5, v0
    v_lshl_add_u32 v2, v3, 7, v2
    v_and_b32 v4, 7, v0
    v_lshl_add_u32 v2, v4, 4, v2
    s_mov_b32 s9, s34
    s_mul_i32 s8, s9, 12544
    s_add_u32 s8, s8, s42
    s_add_u32 s8, s8, 129536
    v_add_u32 v32, s8, v2
    s_add_u32 s9, s9, 1
    s_cmp_eq_u32 s9, 5
    s_cselect_b32 s9, 0, s9
    s_mul_i32 s8, s9, 12544
    s_add_u32 s8, s8, s42
    s_add_u32 s8, s8, 129536
    v_add_u32 v33, s8, v2
    s_add_u32 s9, s9, 1
    s_cmp_eq_u32 s9, 5
    s_cselect_b32 s9, 0, s9
    s_mul_i32 s8, s9, 12544
    s_add_u32 s8, s8, s42
    s_add_u32 s8, s8, 129536
    v_add_u32 v34, s8, v2
    s_add_u32 s9, s9, 1
    s_cmp_eq_u32 s9, 5
    s_cselect_b32 s9, 0, s9
    s_mul_i32 s8, s9, 12544
    s_add_u32 s8, s8, s42
    s_add_u32 s8, s8, 129536
    v_add_u32 v35, s8, v2
    s_add_u32 s9, s9, 1
    s_cmp_eq_u32 s9, 5
    s_cselect_b32 s9, 0, s9
    s_mul_i32 s8, s9, 12544
    s_add_u32 s8, s8, s42
    s_add_u32 s8, s8, 129536
    v_add_u32 v36, s8, v2
    v_lshlrev_b32 v11, 8, v3
    v_and_b32 v4, 31, v0
    v_lshl_add_u32 v11, v4, 3, v11
L_h0_nod:
    s_barrier
    s_cmp_lt_u32 s24, 12
    s_cbranch_scc1 L_h0_nob
    s_mov_b32 s19, 96
    s_mov_b32 s18, 0
Lg_254:
    global_load_dwordx4 v[48:51], v40, s[4:5] offset:0 sc1
    global_load_dwordx4 v[52:55], v41, s[4:5] offset:0 sc1
    global_load_dwordx4 v[56:59], v42, s[4:5] offset:0 sc1
    global_load_dwordx4 v[60:63], v43, s[4:5] offset:0 sc1
    s_add_u32 s18, s18, 1
    s_cmp_gt_u32 s18, 40000
    s_cbranch_scc1 L_fail
    s_waitcnt vmcnt(0)
    v_lshl_add_u64 v[48:49], v[48:49], 0, s[96:97]
    v_lshl_add_u64 v[50:51], v[50:51], 0, s[96:97]
    v_lshl_add_u64 v[52:53], v[52:53], 0, s[96:97]
    v_lshl_add_u64 v[54:55], v[54:55], 0, s[96:97]
    v_lshl_add_u64 v[56:57], v[56:57], 0, s[96:97]
    v_lshl_add_u64 v[58:59], v[58:59], 0, s[96:97]
    v_lshl_add_u64 v[60:61], v[60:61], 0, s[96:97]
    v_lshl_add_u64 v[62:63], v[62:63], 0, s[96:97]
    v_or3_b32 v2, v48, v49, v50
    v_or3_b32 v2, v2, v51, v52
    v_or3_b32 v2, v2, v53, v54
    v_or3_b32 v2, v2, v55, v56
    v_or3_b32 v2, v2, v57, v58
    v_or3_b32 v2, v2, v59, v60
    v_or3_b32 v2, v2, v61, v62
    v_or_b32 v2, v2, v63
    v_cmp_ne_u32_sdwa vcc, v2, 0 src0_sel:BYTE_0 src1_sel:DWORD
    s_cbranch_vccnz Lg_254
    v_pk_add_f32 v[48:49], v[48:49], v[52:53]
    v_pk_add_f32 v[50:51], v[50:51], v[54:55]
    v_pk_add_f32 v[48:49], v[48:49], v[56:57]
    v_pk_add_f32 v[50:51], v[50:51], v[58:59]
    v_pk_add_f32 v[48:49], v[48:49], v[60:61]
    v_pk_add_f32 v[50:51], v[50:51], v[62:63]
    v_cvt_pk_bf16_f32 v8, v48, v49
    v_cvt_pk_bf16_f32 v9, v50, v51
    ds_write_b64 v10, v[8:9] offset:1024
    s_waitcnt lgkmcnt(0)
    s_barrier
L_h0_nob:
    s_cmp_eq_u32 s43, 0
    s_cbranch_scc1 L_h0_end
    s_mov_b32 s19, 97
    s_mov_b32 s18, 0
Lg_255:
    global_load_dwordx4 v[48:51], v32, s[4:5] offset:0 sc1
    global_load_dwordx4 v[52:55], v33, s[4:5] offset:0 sc1
    global_load_dwordx4 v[56:59], v34, s[4:5] offset:0 sc1
    global_load_dwordx4 v[60:63], v35, s[4:5] offset:0 sc1
    global_load_dwordx4 v[64:67], v36, s[4:5] offset:0 sc1
    s_add_u32 s18, s18, 1
    s_cmp_gt_u32 s18, 40000
    s_cbranch_scc1 L_fail
    s_waitcnt vmcnt(0)
    v_xor_b32 v2, s20, v50
    v_bitop3_b32 v2, v2, v54, s20 bitop3:0xf6
    v_bitop3_b32 v2, v2, v58, s20 bitop3:0xf6
    v_bitop3_b32 v2, v2, v62, s20 bitop3:0xf6
    v_bitop3_b32 v2, v2, v66, s20 bitop3:0xf6
    v_cmp_ne_u32 vcc, 0, v2
    s_cbranch_vccnz Lg_255
    v_mov_b32 v2, 0x3f803f80
    v_mov_b32 v12, 0
    v_mov_b32 v13, 0
    v_dot2c_f32_bf16 v12, v48, v2
    v_dot2c_f32_bf16 v13, v48, v48
    v_dot2c_f32_bf16 v12, v49, v2
    v_dot2c_f32_bf16 v13, v49, v49
    v_dot2c_f32_bf16 v12, v52, v2
    v_dot2c_f32_bf16 v13, v52, v52
    v_dot2c_f32_bf16 v12, v53, v2
    v_dot2c_f32_bf16 v13, v53, v53
    v_dot2c_f32_bf16 v12, v56, v2
    v_dot2c_f32_bf16 v13, v56, v56
    v_dot2c_f32_bf16 v12, v57, v2
    v_dot2c_f32_bf16 v13, v57, v57
    v_dot2c_f32_bf16 v12, v60, v2
    v_dot2c_f32_bf16 v13, v60, v60
    v_dot2c_f32_bf16 v12, v61, v2
    v_dot2c_f32_bf16 v13, v61, v61
    v_dot2c_f32_bf16 v12, v64, v2
    v_dot2c_f32_bf16 v13, v64, v64
    v_dot2c_f32_bf16 v12, v65, v2
    v_dot2c_f32_bf16 v13, v65, v65
    s_nop 1
    v_add_f32_dpp v12, v12, v12 quad_perm:[1,0,3,2] row_mask:0xf bank_mask:0xf
    v_add_f32_dpp v13, v13, v13 quad_perm:[1,0,3,2] row_mask:0xf bank_mask:0xf
    s_nop 0
    v_add_f32_dpp v12, v12, v12 quad_perm:[2,3,0,1] row_mask:0xf bank_mask:0xf
    v_add_f32_dpp v13, v13, v13 quad_perm:[2,3,0,1] row_mask:0xf bank_mask:0xf
    s_nop 0
    v_add_f32_dpp v12, v12, v12 row_half_mirror row_mask:0xf bank_mask:0xf
    v_add_f32_dpp v13, v13, v13 row_half_mirror row_mask:0xf bank_mask:0xf
    s_nop 0
    v_add_f32_dpp v12, v12, v12 row_mirror row_mask:0xf bank_mask:0xf
    v_add_f32_dpp v13, v13, v13 row_mirror row_mask:0xf bank_mask:0xf
    v_mov_b32 v2, v12
    v_mov_b32 v3, v13
    s_nop 0
    v_permlane16_swap_b32 v12, v2
    v_permlane16_swap_b32 v13, v3
    v_add_f32 v12, v12, v2
    v_add_f32 v13, v13, v3
    v_mul_f32 v12, 0x3acccccd, v12
    v_mul_f32 v13, 0x3acccccd, v13
    v_fma_f32 v13, -v12, v12, v13
    v_max_f32 v13, 0, v13
    v_cvt_pk_bf16_f32 v12, 0, v12
    v_cvt_pk_bf16_f32 v13, 0, v13
    v_add_f32 v13, 0x3727c5ac, v13
    v_cvt_pk_bf16_f32 v13, 0, v13
    v_sqrt_f32 v13, v13
    s_nop 0
    v_cvt_pk_bf16_f32 v13, 0, v13
    v_rcp_f32 v13, v13
    v_lshlrev_b32 v16, 16, v48
    v_and_b32 v17, 0xffff0000, v48
    v_lshlrev_b32 v18, 16, v49
    v_and_b32 v19, 0xffff0000, v49
    v_pk_add_f32 v[16:17], v[16:17], v[12:13] op_sel_hi:[1,0] neg_lo:[0,1] neg_hi:[0,1]
    v_pk_add_f32 v[18:19], v[18:19], v[12:13] op_sel_hi:[1,0] neg_lo:[0,1] neg_hi:[0,1]
    v_cvt_pk_bf16_f32 v16, 0, v16
    v_cvt_pk_bf16_f32 v17, 0, v17
    v_cvt_pk_bf16_f32 v18, 0, v18
    v_cvt_pk_bf16_f32 v19, 0, v19
    v_pk_mul_f32 v[16:17], v[16:17], v[12:13] op_sel:[0,1] op_sel_hi:[1,1]
    v_pk_mul_f32 v[18:19], v[18:19], v[12:13] op_sel:[0,1] op_sel_hi:[1,1]
    v_cvt_pk_bf16_f32 v16, 0, v16
    v_cvt_pk_bf16_f32 v17, 0, v17
    v_cvt_pk_bf16_f32 v18, 0, v18
    v_cvt_pk_bf16_f32 v19, 0, v19
    v_pk_mul_f32 v[16:17], v[16:17], v[24:25]
    v_pk_mul_f32 v[18:19], v[18:19], v[26:27]
    v_cvt_pk_bf16_f32 v16, 0, v16
    v_cvt_pk_bf16_f32 v17, 0, v17
    v_cvt_pk_bf16_f32 v18, 0, v18
    v_cvt_pk_bf16_f32 v19, 0, v19
    v_pk_add_f32 v[16:17], v[16:17], v[28:29]
    v_pk_add_f32 v[18:19], v[18:19], v[30:31]
    v_cvt_pk_bf16_f32 v2, v16, v17
    v_cvt_pk_bf16_f32 v3, v18, v19
    ds_write_b64 v11, v[2:3] offset:2048
    s_waitcnt lgkmcnt(0)
    s_barrier
    v_lshlrev_b32 v2, 4, v0
    s_cmp_lt_u32 s35, 3
    s_cselect_b32 s8, s35, 15
    s_cselect_b32 s9, 3, 1
    s_mul_i32 s8, s8, 6272
    s_mul_i32 s9, s9, 6272
    s_add_u32 s8, s8, s42
    s_add_u32 s8, s8, 1024
    v_add_u32 v40, s8, v2
    s_add_u32 s8, s8, s9
    v_add_u32 v41, s8, v2
    s_add_u32 s8, s8, s9
    v_add_u32 v42, s8, v2
    s_add_u32 s8, s8, s9
    v_add_u32 v43, s8, v2
    s_add_u32 s8, s8, s9
    v_add_u32 v44, s8, v2
    v_bfe_u32 v2, v0, 2, 1
    v_lshlrev_b32 v11, 7, v2
    v_bfe_u32 v2, v0, 3, 2
    v_lshl_add_u32 v11, v2, 5, v11
    v_and_b32 v2, 3, v0
    v_lshl_add_u32 v11, v2, 3, v11
    v_lshrrev_b32 v2, 5, v0
    v_lshl_add_u32 v11, v2, 2, v11
    s_mov_b32 s10, 0x3d372713
    s_mov_b32 s11, 0x3d372713
    s_mov_b32 s12, 0xc0135761
    s_mov_b32 s13, 0xc0135761
    s_mov_b32 s19, 98
    s_mov_b32 s18, 0
Lg_256:
    global_load_dwordx4 v[48:51], v40, s[4:5] offset:0 sc1
    global_load_dwordx4 v[52:55], v41, s[4:5] offset:0 sc1
    global_load_dwordx4 v[56:59], v42, s[4:5] offset:0 sc1
    global_load_dwordx4 v[60:63], v43, s[4:5] offset:0 sc1
    global_load_dwordx4 v[64:67], v44, s[4:5] offset:0 sc1
    s_add_u32 s18, s18, 1
    s_cmp_gt_u32 s18, 40000
    s_cbranch_scc1 L_fail
    s_waitcnt vmcnt(0)
    v_lshl_add_u64 v[48:49], v[48:49], 0, s[96:97]
    v_lshl_add_u64 v[50:51], v[50:51], 0, s[96:97]
    v_lshl_add_u64 v[52:53], v[52:53], 0, s[96:97]
    v_lshl_add_u64 v[54:55], v[54:55], 0, s[96:97]
    v_lshl_add_u64 v[56:57], v[56:57], 0, s[96:97]
    v_lshl_add_u64 v[58:59], v[58:59], 0, s[96:97]
    v_lshl_add_u64 v[60:61], v[60:61], 0, s[96:97]
    v_lshl_add_u64 v[62:63], v[62:63], 0, s[96:97]
    v_lshl_add_u64 v[64:65], v[64:65], 0, s[96:97]
    v_lshl_add_u64 v[66:67], v[66:67], 0, s[96:97]
    v_or3_b32 v2, v48, v49, v50
    v_or3_b32 v2, v2, v51, v52
    v_or3_b32 v2, v2, v53, v54
    v_or3_b32 v2, v2, v55, v56
    v_or3_b32 v2, v2, v57, v58
    v_or3_b32 v2, v2, v59, v60
    v_or3_b32 v2, v2, v61, v62
    v_or3_b32 v2, v2, v63, v64
    v_or3_b32 v2, v2, v65, v66
    v_or_b32 v2, v2, v67
    v_cmp_ne_u32_sdwa vcc, v2, 0 src0_sel:BYTE_0 src1_sel:DWORD
    s_cbranch_vccnz Lg_256
    v_pk_add_f32 v[48:49], v[48:49], v[52:53]
    v_pk_add_f32 v[50:51], v[50:51], v[54:55]
    v_pk_add_f32 v[48:49], v[48:49], v[56:57]
    v_pk_add_f32 v[50:51], v[50:51], v[58:59]
    v_pk_add_f32 v[48:49], v[48:49], v[60:61]
    v_pk_add_f32 v[50:51], v[50:51], v[62:63]
    v_pk_add_f32 v[48:49], v[48:49], v[64:65]
    v_pk_add_f32 v[50:51], v[50:51], v[66:67]
    v_cvt_pk_bf16_f32 v2, v48, v49
    v_cvt_pk_bf16_f32 v3, v50, v51
    s_nop 1
    v_permlane32_swap_b32 v2, v3
    v_lshlrev_b32 v48, 16, v2
    v_and_b32 v49, 0xffff0000, v2
    v_pk_mul_f32 v[52:53], v[48:49], v[48:49]
    v_lshlrev_b32 v50, 16, v3
    v_and_b32 v51, 0xffff0000, v3
    v_pk_mul_f32 v[52:53], v[52:53], s[10:11]
    v_pk_fma_f32 v[52:53], v[52:53], v[48:49], v[48:49]
    v_pk_mul_f32 v[52:53], v[52:53], s[12:13]
    v_exp_f32 v52, v52
    v_exp_f32 v53, v53
    v_add_f32 v52, 1.0, v52
    v_add_f32 v53, 1.0, v53
    v_rcp_f32 v52, v52
    v_rcp_f32 v53, v53
    s_nop 0
    v_pk_mul_f32 v[48:49], v[48:49], v[52:53]
    v_cvt_pk_bf16_f32 v48, 0, v48
    v_cvt_pk_bf16_f32 v49, 0, v49
    v_pk_mul_f32 v[48:49], v[48:49], v[50:51]
    v_cvt_pk_bf16_f32 v2, v48, v49
    ds_write_b32 v11, v2 offset:2560
    s_waitcnt lgkmcnt(0)
    s_barrier
L_h0_end:
    s_endpgm
L_don_end:
    s_waitcnt vmcnt(4)
    v_and_b32_dpp v16, v30, v8 row_newbcast:4 row_mask:0xf bank_mask:0xf
    v_and_b32_dpp v17, v30, v9 row_newbcast:4 row_mask:0xf bank_mask:0xf
    v_and_b32_dpp v18, v30, v10 row_newbcast:4 row_mask:0xf bank_mask:0xf
    v_and_b32_dpp v19, v30, v11 row_newbcast:4 row_mask:0xf bank_mask:0xf
    s_nop 1
    v_mfma_f32_16x16x32_bf16 v[20:23], v[140:143], v[16:19], v[20:23]
    s_waitcnt vmcnt(3)
    v_and_b32_dpp v12, v30, v8 row_newbcast:8 row_mask:0xf bank_mask:0xf
    v_and_b32_dpp v13, v30, v9 row_newbcast:8 row_mask:0xf bank_mask:0xf
    v_and_b32_dpp v14, v30, v10 row_newbcast:8 row_mask:0xf bank_mask:0xf
    v_and_b32_dpp v15, v30, v11 row_newbcast:8 row_mask:0xf bank_mask:0xf
    s_nop 1
    v_mfma_f32_16x16x32_bf16 v[20:23], v[144:147], v[12:15], v[20:23]
    s_waitcnt vmcnt(2)
    v_and_b32_dpp v16, v30, v8 row_newbcast:12 row_mask:0xf bank_mask:0xf
    v_and_b32_dpp v17, v30, v9 row_newbcast:12 row_mask:0xf bank_mask:0xf
    v_and_b32_dpp v18, v30, v10 row_newbcast:12 row_mask:0xf bank_mask:0xf
    v_and_b32_dpp v19, v30, v11 row_newbcast:12 row_mask:0xf bank_mask:0xf
    s_nop 1
    v_mfma_f32_16x16x32_bf16 v[20:23], v[148:151], v[16:19], v[20:23]
    s_waitcnt vmcnt(1)
    v_and_b32_dpp v12, v31, v8 row_newbcast:0 row_mask:0xf bank_mask:0xf
    v_and_b32_dpp v13, v31, v9 row_newbcast:0 row_mask:0xf bank_mask:0xf
    v_and_b32_dpp v14, v31, v10 row_newbcast:0 row_mask:0xf bank_mask:0xf
    v_and_b32_dpp v15, v31, v11 row_newbcast:0 row_mask:0xf bank_mask:0xf
    s_nop 1
    v_mfma_f32_16x16x32_bf16 v[20:23], v[152:155], v[12:15], v[20:23]
    s_waitcnt vmcnt(0)
    v_and_b32_dpp v16, v31, v8 row_newbcast:4 row_mask:0xf bank_mask:0xf
    v_and_b32_dpp v17, v31, v9 row_newbcast:4 row_mask:0xf bank_mask:0xf
    v_and_b32_dpp v18, v31, v10 row_newbcast:4 row_mask:0xf bank_mask:0xf
    v_and_b32_dpp v19, v31, v11 row_newbcast:4 row_mask:0xf bank_mask:0xf
    s_nop 1
    v_mfma_f32_16x16x32_bf16 v[20:23], v[156:159], v[16:19], v[20:23]
    s_branch L_pv_end
L_recv_end:
    s_sub_u32 s54, s6, s53
    s_subb_u32 s55, s7, 0
    v_lshrrev_b32 v36, 4, v0
    v_lshlrev_b32 v36, 2, v36
    s_lshl_b32 s8, s3, 6
    s_add_u32 s8, s8, 122880
    v_add_u32 v36, s8, v36
    s_waitcnt vmcnt(3)
    global_load_dwordx4 v[40:43], v2, s[54:55] offset:2048 nt
    v_and_b32_dpp v16, v30, v8 row_newbcast:12 row_mask:0xf bank_mask:0xf
    v_and_b32_dpp v17, v30, v9 row_newbcast:12 row_mask:0xf bank_mask:0xf
    v_and_b32_dpp v18, v30, v10 row_newbcast:12 row_mask:0xf bank_mask:0xf
    v_and_b32_dpp v19, v30, v11 row_newbcast:12 row_mask:0xf bank_mask:0xf
    s_nop 1
    v_mfma_f32_16x16x32_bf16 v[20:23], v[148:151], v[16:19], v[20:23]
    v_and_b32_dpp v12, v31, v8 row_newbcast:0 row_mask:0xf bank_mask:0xf
    v_and_b32_dpp v13, v31, v9 row_newbcast:0 row_mask:0xf bank_mask:0xf
    v_and_b32_dpp v14, v31, v10 row_newbcast:0 row_mask:0xf bank_mask:0xf
    v_and_b32_dpp v15, v31, v11 row_newbcast:0 row_mask:0xf bank_mask:0xf
    s_nop 1
    v_mfma_f32_16x16x32_bf16 v[20:23], v[152:155], v[12:15], v[20:23]
    s_waitcnt vmcnt(3)
    global_load_dwordx4 v[44:47], v2, s[54:55] offset:3072 nt
    v_and_b32_dpp v16, v31, v8 row_newbcast:4 row_mask:0xf bank_mask:0xf
    v_and_b32_dpp v17, v31, v9 row_newbcast:4 row_mask:0xf bank_mask:0xf
    v_and_b32_dpp v18, v31, v10 row_newbcast:4 row_mask:0xf bank_mask:0xf
    v_and_b32_dpp v19, v31, v11 row_newbcast:4 row_mask:0xf bank_mask:0xf
    s_nop 1
    v_mfma_f32_16x16x32_bf16 v[20:23], v[156:159], v[16:19], v[20:23]
    v_mov_b32 v3, 0
    s_mov_b32 s19, 25
    s_mov_b32 s18, 0
Llds_167:
    ds_read_b32 v6, v3 offset:52
    s_add_u32 s18, s18, 1
    s_cmp_gt_u32 s18, 400000
    s_cbranch_scc1 L_fail
    s_waitcnt lgkmcnt(0)
    v_readfirstlane_b32 s8, v6
    s_cmp_lt_u32 s8, 1
    s_cbranch_scc1 Llds_167
    ds_read_b32 v32, v36 offset:32
    ds_read_b32 v33, v36 offset:48
    s_waitcnt vmcnt(3)
    v_and_b32_dpp v12, v31, v8 row_newbcast:8 row_mask:0xf bank_mask:0xf
    v_and_b32_dpp v13, v31, v9 row_newbcast:8 row_mask:0xf bank_mask:0xf
    v_and_b32_dpp v14, v31, v10 row_newbcast:8 row_mask:0xf bank_mask:0xf
    v_and_b32_dpp v15, v31, v11 row_newbcast:8 row_mask:0xf bank_mask:0xf
    s_nop 1
    v_mfma_f32_16x16x32_bf16 v[20:23], v[160:163], v[12:15], v[20:23]
    s_waitcnt vmcnt(2)
    v_and_b32_dpp v16, v31, v8 row_newbcast:12 row_mask:0xf bank_mask:0xf
    v_and_b32_dpp v17, v31, v9 row_newbcast:12 row_mask:0xf bank_mask:0xf
    v_and_b32_dpp v18, v31, v10 row_newbcast:12 row_mask:0xf bank_mask:0xf
    v_and_b32_dpp v19, v31, v11 row_newbcast:12 row_mask:0xf bank_mask:0xf
    s_nop 1
    v_mfma_f32_16x16x32_bf16 v[20:23], v[164:167], v[16:19], v[20:23]
    s_waitcnt lgkmcnt(0)
    v_and_b32 v12, v32, v8
    v_and_b32 v13, v32, v9
    v_and_b32 v14, v32, v10
    v_and_b32 v15, v32, v11
    s_waitcnt vmcnt(1)
    s_nop 0
    v_mfma_f32_16x16x32_bf16 v[20:23], v[40:43], v[12:15], v[20:23]
    v_and_b32 v16, v33, v8
    v_and_b32 v17, v33, v9
    v_and_b32 v18, v33, v10
    v_and_b32 v19, v33, v11
    s_waitcnt vmcnt(0)
    s_nop 0
    v_mfma_f32_16x16x32_bf16 v[20:23], v[44:47], v[16:19], v[20:23]
    s_branch L_pv_end
Lg_174:
    global_store_dwordx4 v3, v[104:107], s[4:5] sc1
    s_branch Lj_175
Lg_202:
    global_store_dwordx4 v10, v[128:131], s[4:5] sc1
    global_store_dwordx4 v10, v[132:135], s[4:5] offset:64 sc1
    s_branch Lj_203
Lg_206:
    global_store_dwordx2 v13, v[16:17], s[4:5] sc1
    s_branch Lj_207
Lg_226:
    global_store_dwordx4 v20, v[2:5], s[4:5] sc1
    s_branch Lj_227
Lg_242:
    global_store_dwordx4 v2, v[10:13], s[4:5] sc1
    s_branch Lj_243
Lg_245:
    global_store_dwordx4 v3, v[48:51], s[4:5] sc1
    s_branch Lj_246
L_fail:
    s_load_dwordx2 s[12:13], s[0:1], 96
    s_mov_b64 exec, 1
    s_lshl_b32 s8, s2, 8
    s_or_b32 s8, s8, s19
    s_lshl_b32 s9, s3, 24
    s_or_b32 s8, s8, s9
    v_mov_b32 v1, s8
    s_and_b32 s9, s19, 0x3f
    s_lshl_b32 s9, s9, 2
    v_mov_b32 v0, s9
    s_waitcnt lgkmcnt(0)
    global_store_dword v0, v1, s[12:13]
L_exit:
    s_endpgm
.section .rodata,"a"
.p2align 6
.amdhsa_kernel adaLN_cond__sliding_block_cached__geglu_ffn__decode_kernel
  .amdhsa_next_free_vgpr 168
  .amdhsa_next_free_sgpr 102
  .amdhsa_accum_offset 168
  .amdhsa_group_segment_fixed_size 0
  .amdhsa_kernarg_size 112
  .amdhsa_user_sgpr_count 2
  .amdhsa_user_sgpr_kernarg_segment_ptr 1
  .amdhsa_system_sgpr_workgroup_id_x 1
.end_amdhsa_kernel
```
